```python
import torch

def _softmax(x, axis=-1):
    return torch.softmax(x, dim=axis)
def _gelu(x):
    return torch.nn.functional.gelu(x, approximate="tanh")
def _silu(x):
    return torch.nn.functional.silu(x)
def _sigmoid(x):
    return torch.sigmoid(x)
def _layernorm(x, axis=-1, eps=1e-5):
    m = x.mean(dim=axis, keepdim=True)
    v = x.var(dim=axis, keepdim=True, unbiased=False)
    return (x - m) / torch.sqrt(v + eps)
def _scatter_add(tgt, idx, src, axis=0):
    return tgt.clone().index_add_(axis, idx, src)
def _segment_sum(src, seg, n):
    out = torch.zeros((n,) + src.shape[1:], dtype=src.dtype)
    return out.index_add_(0, seg, src)
def _pad(x, pw):
    flat = tuple(v for pair in reversed(pw) for v in pair)
    return torch.nn.functional.pad(x, flat)

kernel_name = 'parallel_sum__gqa_block_cached__geglu_ffn__decode'

def setup_inputs():

    _w = (lambda a: (lambda t: t.to(torch.bfloat16) if t.is_floating_point() else t)(torch.as_tensor(a)))
    def _A_setup():
        B, Sq, D = 2, 1, 448
        Hq, Hkv, Sk, Dh = 16, 8, 32768, 256
        assert Hq % Hkv == 0, (Hq, Hkv)
        return {
            "x": _w((lambda *s: torch.randn(*s, dtype=torch.bfloat16) * 0.05)(B, Sq, D)),
            "k_cache": _w((lambda *s: torch.randn(*s, dtype=torch.bfloat16) * 3.2)(B, Hkv, Sk, Dh)),
            "v_cache": _w((lambda *s: torch.randn(*s, dtype=torch.bfloat16) * 1.6)(B, Hkv, Sk, Dh)),
            "wq": _w((lambda *s: torch.randn(*s, dtype=torch.bfloat16) * 3.2)(D, Hq * Dh) * (D ** -0.5)),
            "wo": _w((lambda *s: torch.randn(*s, dtype=torch.bfloat16) * 1.6)(Hq * Dh, D) * ((Hq * Dh) ** -0.5)),
        }
    _A_in = _A_setup()

    def _B_setup():
        B, S, D, F = 2, 1, 448, 1792
        return {
            "x": _w((lambda *s: torch.randn(*s, dtype=torch.bfloat16) * 0.05)(B, S, D)),
            "w_gate": _w((lambda *s: torch.randn(*s, dtype=torch.bfloat16) * 0.05)(D, F)),
            "w_up": _w((lambda *s: torch.randn(*s, dtype=torch.bfloat16) * 0.05)(D, F)),
            "w_down": _w((lambda *s: torch.randn(*s, dtype=torch.bfloat16) * 0.05)(F, D)),
        }
    _B_in = _B_setup()

    return {
        "A_x": _A_in["x"],
        "A_k_cache": _A_in["k_cache"],
        "A_v_cache": _A_in["v_cache"],
        "A_wq": _A_in["wq"],
        "A_wo": _A_in["wo"],
        "B_x": _B_in["x"],
        "B_w_gate": _B_in["w_gate"],
        "B_w_up": _B_in["w_up"],
        "B_w_down": _B_in["w_down"],
    }

def reference(A_x, A_k_cache, A_v_cache, A_wq, A_wo, B_x, B_w_gate, B_w_up, B_w_down):
    def _A_ref(x, k_cache, v_cache, wq, wo):
        B, Sq, D = x.shape
        Hq, Dh = 16, 256
        Hkv = k_cache.shape[1]
        rep = Hq // Hkv
        q = (lambda x, *d: x.permute(*d))((x @ wq).reshape(B, Sq, Hq, Dh), 0, 2, 1, 3)
        k = (lambda x, n, axis: torch.repeat_interleave(x, n, dim=axis))(k_cache, rep, axis=1)
        v = (lambda x, n, axis: torch.repeat_interleave(x, n, dim=axis))(v_cache, rep, axis=1)
        scores = torch.einsum("bhqd,bhkd->bhqk", q, k) * (Dh ** -0.5)
        p = _softmax(scores, axis=-1)
        o = torch.einsum("bhqk,bhkd->bhqd", p, v)
        return (lambda x, *d: x.permute(*d))(o, 0, 2, 1, 3).reshape(B, Sq, Hq * Dh) @ wo

    def _B_ref(x, w_gate, w_up, w_down):
        return (_gelu(x @ w_gate) * (x @ w_up)) @ w_down

    x = A_x
    xn = _layernorm(x, axis=-1)
    return x + _A_ref(xn, A_k_cache, A_v_cache, A_wq, A_wo) + _B_ref(xn, B_w_gate, B_w_up, B_w_down)
```

```asm
; @launch kernel=proj_kernel grid=(120,1,1) block=(256,1,1) lds=20480
; @launch kernel=attn_kernel grid=(512,1,1) block=(256,1,1) lds=16640
; @launch kernel=out_kernel grid=(92,1,1) block=(256,1,1) lds=20992
.amdgcn_target "amdgcn-amd-amdhsa--gfx950"
.text
.globl proj_kernel
.p2align 8
.type proj_kernel,@function
proj_kernel:
    s_cmp_ge_u32 s2, 120
    s_cbranch_scc1 LA_end
    s_load_dwordx2 s[4:5], s[0:1], 0
    s_load_dwordx2 s[6:7], s[0:1], 24
    s_load_dwordx4 s[8:11], s[0:1], 48
    s_load_dwordx2 s[12:13], s[0:1], 88
    v_and_b32 v1, 63, v0
    v_lshrrev_b32 v2, 6, v0
    s_waitcnt lgkmcnt(0)
    s_mov_b32 s16, s6
    s_mov_b32 s17, s7
    s_mov_b32 s20, 8192
    s_mov_b32 s21, s2
    s_mov_b32 s18, 3670016
    s_sub_u32 s22, s2, 64
    s_cmp_ge_u32 s2, 64
    s_cselect_b32 s16, s8, s16
    s_cselect_b32 s17, s9, s17
    s_cselect_b32 s20, 3584, s20
    s_cselect_b32 s18, 1605632, s18
    s_cselect_b32 s21, s22, s21
    s_sub_u32 s22, s2, 92
    s_cmp_ge_u32 s2, 92
    s_cselect_b32 s16, s10, s16
    s_cselect_b32 s17, s11, s17
    s_cselect_b32 s21, s22, s21
    s_and_b32 s17, s17, 0xffff
    s_mov_b32 s19, 0x20000
    s_mov_b32 s24, s4
    s_and_b32 s25, s5, 0xffff
    s_mov_b32 s26, 1792
    s_mov_b32 s27, 0x20000
    s_mov_b32 s28, s12
    s_and_b32 s29, s13, 0xffff
    s_mov_b32 s30, 1073741824
    s_mov_b32 s31, 0x20000
    v_lshrrev_b32 v3, 3, v1
    v_and_b32 v4, 7, v1
    v_mul_u32_u24 v5, 112, v2
    v_add_u32 v5, v5, v3
    v_mul_lo_u32 v6, v5, s20
    s_lshl_b32 s22, s21, 7
    v_lshlrev_b32 v7, 4, v4
    v_add3_u32 v6, v6, v7, s22
    s_lshl_b32 s23, s20, 3
    s_mov_b32 s22, 0
    buffer_load_dwordx4 v[64:67], v6, s[16:19], s22 offen
    s_add_u32 s22, s22, s23
    buffer_load_dwordx4 v[68:71], v6, s[16:19], s22 offen
    s_add_u32 s22, s22, s23
    buffer_load_dwordx4 v[72:75], v6, s[16:19], s22 offen
    s_add_u32 s22, s22, s23
    buffer_load_dwordx4 v[76:79], v6, s[16:19], s22 offen
    s_add_u32 s22, s22, s23
    buffer_load_dwordx4 v[80:83], v6, s[16:19], s22 offen
    s_add_u32 s22, s22, s23
    buffer_load_dwordx4 v[84:87], v6, s[16:19], s22 offen
    s_add_u32 s22, s22, s23
    buffer_load_dwordx4 v[88:91], v6, s[16:19], s22 offen
    s_add_u32 s22, s22, s23
    buffer_load_dwordx4 v[92:95], v6, s[16:19], s22 offen
    s_add_u32 s22, s22, s23
    buffer_load_dwordx4 v[96:99], v6, s[16:19], s22 offen
    s_add_u32 s22, s22, s23
    buffer_load_dwordx4 v[100:103], v6, s[16:19], s22 offen
    s_add_u32 s22, s22, s23
    buffer_load_dwordx4 v[104:107], v6, s[16:19], s22 offen
    s_add_u32 s22, s22, s23
    buffer_load_dwordx4 v[108:111], v6, s[16:19], s22 offen
    s_add_u32 s22, s22, s23
    buffer_load_dwordx4 v[112:115], v6, s[16:19], s22 offen
    s_add_u32 s22, s22, s23
    buffer_load_dwordx4 v[116:119], v6, s[16:19], s22 offen
    v_lshlrev_b32 v8, 4, v1
    v_mov_b32 v9, 0x7fffff00
    v_cmp_gt_u32 vcc, 56, v1
    s_nop 1
    v_cndmask_b32 v8, v9, v8, vcc
    v_cndmask_b32 v10, 0, 1.0, vcc
    buffer_load_dwordx4 v[12:15], v8, s[24:27], 0 offen
    buffer_load_dwordx4 v[16:19], v8, s[24:27], 0 offen offset:896
    s_waitcnt vmcnt(0)
    v_lshlrev_b32 v20, 16, v12
    v_and_b32 v21, 0xffff0000, v12
    v_lshlrev_b32 v22, 16, v13
    v_and_b32 v23, 0xffff0000, v13
    v_lshlrev_b32 v24, 16, v14
    v_and_b32 v25, 0xffff0000, v14
    v_lshlrev_b32 v26, 16, v15
    v_and_b32 v27, 0xffff0000, v15
    v_lshlrev_b32 v28, 16, v16
    v_and_b32 v29, 0xffff0000, v16
    v_lshlrev_b32 v30, 16, v17
    v_and_b32 v31, 0xffff0000, v17
    v_lshlrev_b32 v32, 16, v18
    v_and_b32 v33, 0xffff0000, v18
    v_lshlrev_b32 v34, 16, v19
    v_and_b32 v35, 0xffff0000, v19
    s_mov_b32 s44, 0x3b124925
    v_add_f32 v36, v20, v21
    v_add_f32 v36, v36, v22
    v_add_f32 v36, v36, v23
    v_add_f32 v36, v36, v24
    v_add_f32 v36, v36, v25
    v_add_f32 v36, v36, v26
    v_add_f32 v36, v36, v27
    s_nop 1
    v_add_f32_dpp v36, v36, v36 row_shr:1 row_mask:0xf bank_mask:0xf
    s_nop 1
    v_add_f32_dpp v36, v36, v36 row_shr:2 row_mask:0xf bank_mask:0xf
    s_nop 1
    v_add_f32_dpp v36, v36, v36 row_shr:4 row_mask:0xf bank_mask:0xf
    s_nop 1
    v_add_f32_dpp v36, v36, v36 row_shr:8 row_mask:0xf bank_mask:0xf
    s_nop 1
    v_readlane_b32 s40, v36, 15
    v_readlane_b32 s41, v36, 31
    v_readlane_b32 s42, v36, 47
    v_readlane_b32 s43, v36, 63
    s_nop 1
    v_mov_b32 v36, s40
    v_add_f32 v36, s41, v36
    v_add_f32 v36, s42, v36
    v_add_f32 v36, s43, v36
    v_mul_f32 v40, s44, v36
    v_mov_b32 v36, 0
    v_sub_f32 v37, v20, v40
    v_fmac_f32 v36, v37, v37
    v_sub_f32 v37, v21, v40
    v_fmac_f32 v36, v37, v37
    v_sub_f32 v37, v22, v40
    v_fmac_f32 v36, v37, v37
    v_sub_f32 v37, v23, v40
    v_fmac_f32 v36, v37, v37
    v_sub_f32 v37, v24, v40
    v_fmac_f32 v36, v37, v37
    v_sub_f32 v37, v25, v40
    v_fmac_f32 v36, v37, v37
    v_sub_f32 v37, v26, v40
    v_fmac_f32 v36, v37, v37
    v_sub_f32 v37, v27, v40
    v_fmac_f32 v36, v37, v37
    v_mul_f32 v36, v36, v10
    s_nop 1
    v_add_f32_dpp v36, v36, v36 row_shr:1 row_mask:0xf bank_mask:0xf
    s_nop 1
    v_add_f32_dpp v36, v36, v36 row_shr:2 row_mask:0xf bank_mask:0xf
    s_nop 1
    v_add_f32_dpp v36, v36, v36 row_shr:4 row_mask:0xf bank_mask:0xf
    s_nop 1
    v_add_f32_dpp v36, v36, v36 row_shr:8 row_mask:0xf bank_mask:0xf
    s_nop 1
    v_readlane_b32 s40, v36, 15
    v_readlane_b32 s41, v36, 31
    v_readlane_b32 s42, v36, 47
    v_readlane_b32 s43, v36, 63
    s_nop 1
    v_mov_b32 v36, s40
    v_add_f32 v36, s41, v36
    v_add_f32 v36, s42, v36
    v_add_f32 v36, s43, v36
    v_mul_f32 v36, s44, v36
    v_cvt_pk_bf16_f32 v37, v36, v36
    v_lshlrev_b32 v36, 16, v37
    v_add_f32 v36, 0x3727c5ac, v36
    v_cvt_pk_bf16_f32 v37, v36, v36
    v_lshlrev_b32 v36, 16, v37
    v_sqrt_f32 v36, v36
    s_nop 0
    v_cvt_pk_bf16_f32 v37, v36, v36
    v_lshlrev_b32 v36, 16, v37
    v_rcp_f32 v42, v36
    v_cvt_pk_bf16_f32 v37, v40, v40
    v_lshlrev_b32 v40, 16, v37
    v_sub_f32 v20, v20, v40
    v_sub_f32 v21, v21, v40
    v_sub_f32 v22, v22, v40
    v_sub_f32 v23, v23, v40
    v_sub_f32 v24, v24, v40
    v_sub_f32 v25, v25, v40
    v_sub_f32 v26, v26, v40
    v_sub_f32 v27, v27, v40
    v_cvt_pk_bf16_f32 v37, v20, v21
    v_lshlrev_b32 v20, 16, v37
    v_and_b32 v21, 0xffff0000, v37
    v_cvt_pk_bf16_f32 v37, v22, v23
    v_lshlrev_b32 v22, 16, v37
    v_and_b32 v23, 0xffff0000, v37
    v_cvt_pk_bf16_f32 v37, v24, v25
    v_lshlrev_b32 v24, 16, v37
    v_and_b32 v25, 0xffff0000, v37
    v_cvt_pk_bf16_f32 v37, v26, v27
    v_lshlrev_b32 v26, 16, v37
    v_and_b32 v27, 0xffff0000, v37
    v_mul_f32 v20, v20, v42
    v_mul_f32 v21, v21, v42
    v_mul_f32 v22, v22, v42
    v_mul_f32 v23, v23, v42
    v_mul_f32 v24, v24, v42
    v_mul_f32 v25, v25, v42
    v_mul_f32 v26, v26, v42
    v_mul_f32 v27, v27, v42
    v_cvt_pk_bf16_f32 v37, v20, v21
    v_lshlrev_b32 v20, 16, v37
    v_and_b32 v21, 0xffff0000, v37
    v_cvt_pk_bf16_f32 v37, v22, v23
    v_lshlrev_b32 v22, 16, v37
    v_and_b32 v23, 0xffff0000, v37
    v_cvt_pk_bf16_f32 v37, v24, v25
    v_lshlrev_b32 v24, 16, v37
    v_and_b32 v25, 0xffff0000, v37
    v_cvt_pk_bf16_f32 v37, v26, v27
    v_lshlrev_b32 v26, 16, v37
    v_and_b32 v27, 0xffff0000, v37
    v_add_f32 v36, v28, v29
    v_add_f32 v36, v36, v30
    v_add_f32 v36, v36, v31
    v_add_f32 v36, v36, v32
    v_add_f32 v36, v36, v33
    v_add_f32 v36, v36, v34
    v_add_f32 v36, v36, v35
    s_nop 1
    v_add_f32_dpp v36, v36, v36 row_shr:1 row_mask:0xf bank_mask:0xf
    s_nop 1
    v_add_f32_dpp v36, v36, v36 row_shr:2 row_mask:0xf bank_mask:0xf
    s_nop 1
    v_add_f32_dpp v36, v36, v36 row_shr:4 row_mask:0xf bank_mask:0xf
    s_nop 1
    v_add_f32_dpp v36, v36, v36 row_shr:8 row_mask:0xf bank_mask:0xf
    s_nop 1
    v_readlane_b32 s40, v36, 15
    v_readlane_b32 s41, v36, 31
    v_readlane_b32 s42, v36, 47
    v_readlane_b32 s43, v36, 63
    s_nop 1
    v_mov_b32 v36, s40
    v_add_f32 v36, s41, v36
    v_add_f32 v36, s42, v36
    v_add_f32 v36, s43, v36
    v_mul_f32 v41, s44, v36
    v_mov_b32 v36, 0
    v_sub_f32 v37, v28, v41
    v_fmac_f32 v36, v37, v37
    v_sub_f32 v37, v29, v41
    v_fmac_f32 v36, v37, v37
    v_sub_f32 v37, v30, v41
    v_fmac_f32 v36, v37, v37
    v_sub_f32 v37, v31, v41
    v_fmac_f32 v36, v37, v37
    v_sub_f32 v37, v32, v41
    v_fmac_f32 v36, v37, v37
    v_sub_f32 v37, v33, v41
    v_fmac_f32 v36, v37, v37
    v_sub_f32 v37, v34, v41
    v_fmac_f32 v36, v37, v37
    v_sub_f32 v37, v35, v41
    v_fmac_f32 v36, v37, v37
    v_mul_f32 v36, v36, v10
    s_nop 1
    v_add_f32_dpp v36, v36, v36 row_shr:1 row_mask:0xf bank_mask:0xf
    s_nop 1
    v_add_f32_dpp v36, v36, v36 row_shr:2 row_mask:0xf bank_mask:0xf
    s_nop 1
    v_add_f32_dpp v36, v36, v36 row_shr:4 row_mask:0xf bank_mask:0xf
    s_nop 1
    v_add_f32_dpp v36, v36, v36 row_shr:8 row_mask:0xf bank_mask:0xf
    s_nop 1
    v_readlane_b32 s40, v36, 15
    v_readlane_b32 s41, v36, 31
    v_readlane_b32 s42, v36, 47
    v_readlane_b32 s43, v36, 63
    s_nop 1
    v_mov_b32 v36, s40
    v_add_f32 v36, s41, v36
    v_add_f32 v36, s42, v36
    v_add_f32 v36, s43, v36
    v_mul_f32 v36, s44, v36
    v_cvt_pk_bf16_f32 v37, v36, v36
    v_lshlrev_b32 v36, 16, v37
    v_add_f32 v36, 0x3727c5ac, v36
    v_cvt_pk_bf16_f32 v37, v36, v36
    v_lshlrev_b32 v36, 16, v37
    v_sqrt_f32 v36, v36
    s_nop 0
    v_cvt_pk_bf16_f32 v37, v36, v36
    v_lshlrev_b32 v36, 16, v37
    v_rcp_f32 v43, v36
    v_cvt_pk_bf16_f32 v37, v41, v41
    v_lshlrev_b32 v41, 16, v37
    v_sub_f32 v28, v28, v41
    v_sub_f32 v29, v29, v41
    v_sub_f32 v30, v30, v41
    v_sub_f32 v31, v31, v41
    v_sub_f32 v32, v32, v41
    v_sub_f32 v33, v33, v41
    v_sub_f32 v34, v34, v41
    v_sub_f32 v35, v35, v41
    v_cvt_pk_bf16_f32 v37, v28, v29
    v_lshlrev_b32 v28, 16, v37
    v_and_b32 v29, 0xffff0000, v37
    v_cvt_pk_bf16_f32 v37, v30, v31
    v_lshlrev_b32 v30, 16, v37
    v_and_b32 v31, 0xffff0000, v37
    v_cvt_pk_bf16_f32 v37, v32, v33
    v_lshlrev_b32 v32, 16, v37
    v_and_b32 v33, 0xffff0000, v37
    v_cvt_pk_bf16_f32 v37, v34, v35
    v_lshlrev_b32 v34, 16, v37
    v_and_b32 v35, 0xffff0000, v37
    v_mul_f32 v28, v28, v43
    v_mul_f32 v29, v29, v43
    v_mul_f32 v30, v30, v43
    v_mul_f32 v31, v31, v43
    v_mul_f32 v32, v32, v43
    v_mul_f32 v33, v33, v43
    v_mul_f32 v34, v34, v43
    v_mul_f32 v35, v35, v43
    v_cvt_pk_bf16_f32 v37, v28, v29
    v_lshlrev_b32 v28, 16, v37
    v_and_b32 v29, 0xffff0000, v37
    v_cvt_pk_bf16_f32 v37, v30, v31
    v_lshlrev_b32 v30, 16, v37
    v_and_b32 v31, 0xffff0000, v37
    v_cvt_pk_bf16_f32 v37, v32, v33
    v_lshlrev_b32 v32, 16, v37
    v_and_b32 v33, 0xffff0000, v37
    v_cvt_pk_bf16_f32 v37, v34, v35
    v_lshlrev_b32 v34, 16, v37
    v_and_b32 v35, 0xffff0000, v37
    v_lshlrev_b32 v8, 6, v1
    v_mov_b32 v36, v20
    v_mov_b32 v37, v28
    ds_write_b64 v8, v[36:37] offset:0
    s_nop 0
    v_mov_b32 v36, v21
    v_mov_b32 v37, v29
    ds_write_b64 v8, v[36:37] offset:8
    s_nop 0
    v_mov_b32 v36, v22
    v_mov_b32 v37, v30
    ds_write_b64 v8, v[36:37] offset:16
    s_nop 0
    v_mov_b32 v36, v23
    v_mov_b32 v37, v31
    ds_write_b64 v8, v[36:37] offset:24
    s_nop 0
    v_mov_b32 v36, v24
    v_mov_b32 v37, v32
    ds_write_b64 v8, v[36:37] offset:32
    s_nop 0
    v_mov_b32 v36, v25
    v_mov_b32 v37, v33
    ds_write_b64 v8, v[36:37] offset:40
    s_nop 0
    v_mov_b32 v36, v26
    v_mov_b32 v37, v34
    ds_write_b64 v8, v[36:37] offset:48
    s_nop 0
    v_mov_b32 v36, v27
    v_mov_b32 v37, v35
    ds_write_b64 v8, v[36:37] offset:56
    s_nop 0
    s_waitcnt lgkmcnt(0)
    s_barrier
    v_lshlrev_b32 v8, 3, v5
    ds_read_b64 v[128:129], v8 offset:0
    ds_read_b64 v[130:131], v8 offset:64
    ds_read_b64 v[132:133], v8 offset:128
    ds_read_b64 v[134:135], v8 offset:192
    ds_read_b64 v[136:137], v8 offset:256
    ds_read_b64 v[138:139], v8 offset:320
    ds_read_b64 v[140:141], v8 offset:384
    ds_read_b64 v[142:143], v8 offset:448
    ds_read_b64 v[144:145], v8 offset:512
    ds_read_b64 v[146:147], v8 offset:576
    ds_read_b64 v[148:149], v8 offset:640
    ds_read_b64 v[150:151], v8 offset:704
    ds_read_b64 v[152:153], v8 offset:768
    ds_read_b64 v[154:155], v8 offset:832
    v_mov_b32 v44, 0
    v_mov_b32 v45, 0
    v_mov_b32 v46, 0
    v_mov_b32 v47, 0
    v_mov_b32 v48, 0
    v_mov_b32 v49, 0
    v_mov_b32 v50, 0
    v_mov_b32 v51, 0
    v_mov_b32 v52, 0
    v_mov_b32 v53, 0
    v_mov_b32 v54, 0
    v_mov_b32 v55, 0
    v_mov_b32 v56, 0
    v_mov_b32 v57, 0
    v_mov_b32 v58, 0
    v_mov_b32 v59, 0
    s_waitcnt vmcnt(0) lgkmcnt(0)
    v_lshlrev_b32 v36, 16, v64
    v_and_b32 v37, 0xffff0000, v64
    v_fmac_f32 v44, v128, v36
    v_fmac_f32 v45, v128, v37
    v_fmac_f32 v52, v129, v36
    v_fmac_f32 v53, v129, v37
    v_lshlrev_b32 v36, 16, v65
    v_and_b32 v37, 0xffff0000, v65
    v_fmac_f32 v46, v128, v36
    v_fmac_f32 v47, v128, v37
    v_fmac_f32 v54, v129, v36
    v_fmac_f32 v55, v129, v37
    v_lshlrev_b32 v36, 16, v66
    v_and_b32 v37, 0xffff0000, v66
    v_fmac_f32 v48, v128, v36
    v_fmac_f32 v49, v128, v37
    v_fmac_f32 v56, v129, v36
    v_fmac_f32 v57, v129, v37
    v_lshlrev_b32 v36, 16, v67
    v_and_b32 v37, 0xffff0000, v67
    v_fmac_f32 v50, v128, v36
    v_fmac_f32 v51, v128, v37
    v_fmac_f32 v58, v129, v36
    v_fmac_f32 v59, v129, v37
    v_lshlrev_b32 v36, 16, v68
    v_and_b32 v37, 0xffff0000, v68
    v_fmac_f32 v44, v130, v36
    v_fmac_f32 v45, v130, v37
    v_fmac_f32 v52, v131, v36
    v_fmac_f32 v53, v131, v37
    v_lshlrev_b32 v36, 16, v69
    v_and_b32 v37, 0xffff0000, v69
    v_fmac_f32 v46, v130, v36
    v_fmac_f32 v47, v130, v37
    v_fmac_f32 v54, v131, v36
    v_fmac_f32 v55, v131, v37
    v_lshlrev_b32 v36, 16, v70
    v_and_b32 v37, 0xffff0000, v70
    v_fmac_f32 v48, v130, v36
    v_fmac_f32 v49, v130, v37
    v_fmac_f32 v56, v131, v36
    v_fmac_f32 v57, v131, v37
    v_lshlrev_b32 v36, 16, v71
    v_and_b32 v37, 0xffff0000, v71
    v_fmac_f32 v50, v130, v36
    v_fmac_f32 v51, v130, v37
    v_fmac_f32 v58, v131, v36
    v_fmac_f32 v59, v131, v37
    v_lshlrev_b32 v36, 16, v72
    v_and_b32 v37, 0xffff0000, v72
    v_fmac_f32 v44, v132, v36
    v_fmac_f32 v45, v132, v37
    v_fmac_f32 v52, v133, v36
    v_fmac_f32 v53, v133, v37
    v_lshlrev_b32 v36, 16, v73
    v_and_b32 v37, 0xffff0000, v73
    v_fmac_f32 v46, v132, v36
    v_fmac_f32 v47, v132, v37
    v_fmac_f32 v54, v133, v36
    v_fmac_f32 v55, v133, v37
    v_lshlrev_b32 v36, 16, v74
    v_and_b32 v37, 0xffff0000, v74
    v_fmac_f32 v48, v132, v36
    v_fmac_f32 v49, v132, v37
    v_fmac_f32 v56, v133, v36
    v_fmac_f32 v57, v133, v37
    v_lshlrev_b32 v36, 16, v75
    v_and_b32 v37, 0xffff0000, v75
    v_fmac_f32 v50, v132, v36
    v_fmac_f32 v51, v132, v37
    v_fmac_f32 v58, v133, v36
    v_fmac_f32 v59, v133, v37
    v_lshlrev_b32 v36, 16, v76
    v_and_b32 v37, 0xffff0000, v76
    v_fmac_f32 v44, v134, v36
    v_fmac_f32 v45, v134, v37
    v_fmac_f32 v52, v135, v36
    v_fmac_f32 v53, v135, v37
    v_lshlrev_b32 v36, 16, v77
    v_and_b32 v37, 0xffff0000, v77
    v_fmac_f32 v46, v134, v36
    v_fmac_f32 v47, v134, v37
    v_fmac_f32 v54, v135, v36
    v_fmac_f32 v55, v135, v37
    v_lshlrev_b32 v36, 16, v78
    v_and_b32 v37, 0xffff0000, v78
    v_fmac_f32 v48, v134, v36
    v_fmac_f32 v49, v134, v37
    v_fmac_f32 v56, v135, v36
    v_fmac_f32 v57, v135, v37
    v_lshlrev_b32 v36, 16, v79
    v_and_b32 v37, 0xffff0000, v79
    v_fmac_f32 v50, v134, v36
    v_fmac_f32 v51, v134, v37
    v_fmac_f32 v58, v135, v36
    v_fmac_f32 v59, v135, v37
    v_lshlrev_b32 v36, 16, v80
    v_and_b32 v37, 0xffff0000, v80
    v_fmac_f32 v44, v136, v36
    v_fmac_f32 v45, v136, v37
    v_fmac_f32 v52, v137, v36
    v_fmac_f32 v53, v137, v37
    v_lshlrev_b32 v36, 16, v81
    v_and_b32 v37, 0xffff0000, v81
    v_fmac_f32 v46, v136, v36
    v_fmac_f32 v47, v136, v37
    v_fmac_f32 v54, v137, v36
    v_fmac_f32 v55, v137, v37
    v_lshlrev_b32 v36, 16, v82
    v_and_b32 v37, 0xffff0000, v82
    v_fmac_f32 v48, v136, v36
    v_fmac_f32 v49, v136, v37
    v_fmac_f32 v56, v137, v36
    v_fmac_f32 v57, v137, v37
    v_lshlrev_b32 v36, 16, v83
    v_and_b32 v37, 0xffff0000, v83
    v_fmac_f32 v50, v136, v36
    v_fmac_f32 v51, v136, v37
    v_fmac_f32 v58, v137, v36
    v_fmac_f32 v59, v137, v37
    v_lshlrev_b32 v36, 16, v84
    v_and_b32 v37, 0xffff0000, v84
    v_fmac_f32 v44, v138, v36
    v_fmac_f32 v45, v138, v37
    v_fmac_f32 v52, v139, v36
    v_fmac_f32 v53, v139, v37
    v_lshlrev_b32 v36, 16, v85
    v_and_b32 v37, 0xffff0000, v85
    v_fmac_f32 v46, v138, v36
    v_fmac_f32 v47, v138, v37
    v_fmac_f32 v54, v139, v36
    v_fmac_f32 v55, v139, v37
    v_lshlrev_b32 v36, 16, v86
    v_and_b32 v37, 0xffff0000, v86
    v_fmac_f32 v48, v138, v36
    v_fmac_f32 v49, v138, v37
    v_fmac_f32 v56, v139, v36
    v_fmac_f32 v57, v139, v37
    v_lshlrev_b32 v36, 16, v87
    v_and_b32 v37, 0xffff0000, v87
    v_fmac_f32 v50, v138, v36
    v_fmac_f32 v51, v138, v37
    v_fmac_f32 v58, v139, v36
    v_fmac_f32 v59, v139, v37
    v_lshlrev_b32 v36, 16, v88
    v_and_b32 v37, 0xffff0000, v88
    v_fmac_f32 v44, v140, v36
    v_fmac_f32 v45, v140, v37
    v_fmac_f32 v52, v141, v36
    v_fmac_f32 v53, v141, v37
    v_lshlrev_b32 v36, 16, v89
    v_and_b32 v37, 0xffff0000, v89
    v_fmac_f32 v46, v140, v36
    v_fmac_f32 v47, v140, v37
    v_fmac_f32 v54, v141, v36
    v_fmac_f32 v55, v141, v37
    v_lshlrev_b32 v36, 16, v90
    v_and_b32 v37, 0xffff0000, v90
    v_fmac_f32 v48, v140, v36
    v_fmac_f32 v49, v140, v37
    v_fmac_f32 v56, v141, v36
    v_fmac_f32 v57, v141, v37
    v_lshlrev_b32 v36, 16, v91
    v_and_b32 v37, 0xffff0000, v91
    v_fmac_f32 v50, v140, v36
    v_fmac_f32 v51, v140, v37
    v_fmac_f32 v58, v141, v36
    v_fmac_f32 v59, v141, v37
    v_lshlrev_b32 v36, 16, v92
    v_and_b32 v37, 0xffff0000, v92
    v_fmac_f32 v44, v142, v36
    v_fmac_f32 v45, v142, v37
    v_fmac_f32 v52, v143, v36
    v_fmac_f32 v53, v143, v37
    v_lshlrev_b32 v36, 16, v93
    v_and_b32 v37, 0xffff0000, v93
    v_fmac_f32 v46, v142, v36
    v_fmac_f32 v47, v142, v37
    v_fmac_f32 v54, v143, v36
    v_fmac_f32 v55, v143, v37
    v_lshlrev_b32 v36, 16, v94
    v_and_b32 v37, 0xffff0000, v94
    v_fmac_f32 v48, v142, v36
    v_fmac_f32 v49, v142, v37
    v_fmac_f32 v56, v143, v36
    v_fmac_f32 v57, v143, v37
    v_lshlrev_b32 v36, 16, v95
    v_and_b32 v37, 0xffff0000, v95
    v_fmac_f32 v50, v142, v36
    v_fmac_f32 v51, v142, v37
    v_fmac_f32 v58, v143, v36
    v_fmac_f32 v59, v143, v37
    v_lshlrev_b32 v36, 16, v96
    v_and_b32 v37, 0xffff0000, v96
    v_fmac_f32 v44, v144, v36
    v_fmac_f32 v45, v144, v37
    v_fmac_f32 v52, v145, v36
    v_fmac_f32 v53, v145, v37
    v_lshlrev_b32 v36, 16, v97
    v_and_b32 v37, 0xffff0000, v97
    v_fmac_f32 v46, v144, v36
    v_fmac_f32 v47, v144, v37
    v_fmac_f32 v54, v145, v36
    v_fmac_f32 v55, v145, v37
    v_lshlrev_b32 v36, 16, v98
    v_and_b32 v37, 0xffff0000, v98
    v_fmac_f32 v48, v144, v36
    v_fmac_f32 v49, v144, v37
    v_fmac_f32 v56, v145, v36
    v_fmac_f32 v57, v145, v37
    v_lshlrev_b32 v36, 16, v99
    v_and_b32 v37, 0xffff0000, v99
    v_fmac_f32 v50, v144, v36
    v_fmac_f32 v51, v144, v37
    v_fmac_f32 v58, v145, v36
    v_fmac_f32 v59, v145, v37
    v_lshlrev_b32 v36, 16, v100
    v_and_b32 v37, 0xffff0000, v100
    v_fmac_f32 v44, v146, v36
    v_fmac_f32 v45, v146, v37
    v_fmac_f32 v52, v147, v36
    v_fmac_f32 v53, v147, v37
    v_lshlrev_b32 v36, 16, v101
    v_and_b32 v37, 0xffff0000, v101
    v_fmac_f32 v46, v146, v36
    v_fmac_f32 v47, v146, v37
    v_fmac_f32 v54, v147, v36
    v_fmac_f32 v55, v147, v37
    v_lshlrev_b32 v36, 16, v102
    v_and_b32 v37, 0xffff0000, v102
    v_fmac_f32 v48, v146, v36
    v_fmac_f32 v49, v146, v37
    v_fmac_f32 v56, v147, v36
    v_fmac_f32 v57, v147, v37
    v_lshlrev_b32 v36, 16, v103
    v_and_b32 v37, 0xffff0000, v103
    v_fmac_f32 v50, v146, v36
    v_fmac_f32 v51, v146, v37
    v_fmac_f32 v58, v147, v36
    v_fmac_f32 v59, v147, v37
    v_lshlrev_b32 v36, 16, v104
    v_and_b32 v37, 0xffff0000, v104
    v_fmac_f32 v44, v148, v36
    v_fmac_f32 v45, v148, v37
    v_fmac_f32 v52, v149, v36
    v_fmac_f32 v53, v149, v37
    v_lshlrev_b32 v36, 16, v105
    v_and_b32 v37, 0xffff0000, v105
    v_fmac_f32 v46, v148, v36
    v_fmac_f32 v47, v148, v37
    v_fmac_f32 v54, v149, v36
    v_fmac_f32 v55, v149, v37
    v_lshlrev_b32 v36, 16, v106
    v_and_b32 v37, 0xffff0000, v106
    v_fmac_f32 v48, v148, v36
    v_fmac_f32 v49, v148, v37
    v_fmac_f32 v56, v149, v36
    v_fmac_f32 v57, v149, v37
    v_lshlrev_b32 v36, 16, v107
    v_and_b32 v37, 0xffff0000, v107
    v_fmac_f32 v50, v148, v36
    v_fmac_f32 v51, v148, v37
    v_fmac_f32 v58, v149, v36
    v_fmac_f32 v59, v149, v37
    v_lshlrev_b32 v36, 16, v108
    v_and_b32 v37, 0xffff0000, v108
    v_fmac_f32 v44, v150, v36
    v_fmac_f32 v45, v150, v37
    v_fmac_f32 v52, v151, v36
    v_fmac_f32 v53, v151, v37
    v_lshlrev_b32 v36, 16, v109
    v_and_b32 v37, 0xffff0000, v109
    v_fmac_f32 v46, v150, v36
    v_fmac_f32 v47, v150, v37
    v_fmac_f32 v54, v151, v36
    v_fmac_f32 v55, v151, v37
    v_lshlrev_b32 v36, 16, v110
    v_and_b32 v37, 0xffff0000, v110
    v_fmac_f32 v48, v150, v36
    v_fmac_f32 v49, v150, v37
    v_fmac_f32 v56, v151, v36
    v_fmac_f32 v57, v151, v37
    v_lshlrev_b32 v36, 16, v111
    v_and_b32 v37, 0xffff0000, v111
    v_fmac_f32 v50, v150, v36
    v_fmac_f32 v51, v150, v37
    v_fmac_f32 v58, v151, v36
    v_fmac_f32 v59, v151, v37
    v_lshlrev_b32 v36, 16, v112
    v_and_b32 v37, 0xffff0000, v112
    v_fmac_f32 v44, v152, v36
    v_fmac_f32 v45, v152, v37
    v_fmac_f32 v52, v153, v36
    v_fmac_f32 v53, v153, v37
    v_lshlrev_b32 v36, 16, v113
    v_and_b32 v37, 0xffff0000, v113
    v_fmac_f32 v46, v152, v36
    v_fmac_f32 v47, v152, v37
    v_fmac_f32 v54, v153, v36
    v_fmac_f32 v55, v153, v37
    v_lshlrev_b32 v36, 16, v114
    v_and_b32 v37, 0xffff0000, v114
    v_fmac_f32 v48, v152, v36
    v_fmac_f32 v49, v152, v37
    v_fmac_f32 v56, v153, v36
    v_fmac_f32 v57, v153, v37
    v_lshlrev_b32 v36, 16, v115
    v_and_b32 v37, 0xffff0000, v115
    v_fmac_f32 v50, v152, v36
    v_fmac_f32 v51, v152, v37
    v_fmac_f32 v58, v153, v36
    v_fmac_f32 v59, v153, v37
    v_lshlrev_b32 v36, 16, v116
    v_and_b32 v37, 0xffff0000, v116
    v_fmac_f32 v44, v154, v36
    v_fmac_f32 v45, v154, v37
    v_fmac_f32 v52, v155, v36
    v_fmac_f32 v53, v155, v37
    v_lshlrev_b32 v36, 16, v117
    v_and_b32 v37, 0xffff0000, v117
    v_fmac_f32 v46, v154, v36
    v_fmac_f32 v47, v154, v37
    v_fmac_f32 v54, v155, v36
    v_fmac_f32 v55, v155, v37
    v_lshlrev_b32 v36, 16, v118
    v_and_b32 v37, 0xffff0000, v118
    v_fmac_f32 v48, v154, v36
    v_fmac_f32 v49, v154, v37
    v_fmac_f32 v56, v155, v36
    v_fmac_f32 v57, v155, v37
    v_lshlrev_b32 v36, 16, v119
    v_and_b32 v37, 0xffff0000, v119
    v_fmac_f32 v50, v154, v36
    v_fmac_f32 v51, v154, v37
    v_fmac_f32 v58, v155, v36
    v_fmac_f32 v59, v155, v37
    v_lshlrev_b32 v8, 3, v2
    v_add_u32 v8, v8, v3
    v_lshlrev_b32 v8, 9, v8
    v_lshlrev_b32 v9, 5, v4
    v_add_u32 v8, v8, v9
    ds_write_b128 v8, v[44:47] offset:4096
    ds_write_b128 v8, v[48:51] offset:4112
    ds_write_b128 v8, v[52:55] offset:4352
    ds_write_b128 v8, v[56:59] offset:4368
    s_waitcnt lgkmcnt(0)
    s_barrier
    v_cmp_gt_u32 vcc, 128, v0
    s_and_saveexec_b64 s[34:35], vcc
    s_cbranch_execz LA_end
    v_lshlrev_b32 v8, 2, v0
    ds_read_b32 v64, v8 offset:4096
    ds_read_b32 v65, v8 offset:4608
    ds_read_b32 v66, v8 offset:5120
    ds_read_b32 v67, v8 offset:5632
    ds_read_b32 v68, v8 offset:6144
    ds_read_b32 v69, v8 offset:6656
    ds_read_b32 v70, v8 offset:7168
    ds_read_b32 v71, v8 offset:7680
    ds_read_b32 v72, v8 offset:8192
    ds_read_b32 v73, v8 offset:8704
    ds_read_b32 v74, v8 offset:9216
    ds_read_b32 v75, v8 offset:9728
    ds_read_b32 v76, v8 offset:10240
    ds_read_b32 v77, v8 offset:10752
    ds_read_b32 v78, v8 offset:11264
    ds_read_b32 v79, v8 offset:11776
    ds_read_b32 v80, v8 offset:12288
    ds_read_b32 v81, v8 offset:12800
    ds_read_b32 v82, v8 offset:13312
    ds_read_b32 v83, v8 offset:13824
    ds_read_b32 v84, v8 offset:14336
    ds_read_b32 v85, v8 offset:14848
    ds_read_b32 v86, v8 offset:15360
    ds_read_b32 v87, v8 offset:15872
    ds_read_b32 v88, v8 offset:16384
    ds_read_b32 v89, v8 offset:16896
    ds_read_b32 v90, v8 offset:17408
    ds_read_b32 v91, v8 offset:17920
    ds_read_b32 v92, v8 offset:18432
    ds_read_b32 v93, v8 offset:18944
    ds_read_b32 v94, v8 offset:19456
    ds_read_b32 v95, v8 offset:19968
    s_waitcnt lgkmcnt(0)
    v_add_f32 v64, v64, v65
    v_add_f32 v64, v64, v66
    v_add_f32 v64, v64, v67
    v_add_f32 v64, v64, v68
    v_add_f32 v64, v64, v69
    v_add_f32 v64, v64, v70
    v_add_f32 v64, v64, v71
    v_add_f32 v64, v64, v72
    v_add_f32 v64, v64, v73
    v_add_f32 v64, v64, v74
    v_add_f32 v64, v64, v75
    v_add_f32 v64, v64, v76
    v_add_f32 v64, v64, v77
    v_add_f32 v64, v64, v78
    v_add_f32 v64, v64, v79
    v_add_f32 v64, v64, v80
    v_add_f32 v64, v64, v81
    v_add_f32 v64, v64, v82
    v_add_f32 v64, v64, v83
    v_add_f32 v64, v64, v84
    v_add_f32 v64, v64, v85
    v_add_f32 v64, v64, v86
    v_add_f32 v64, v64, v87
    v_add_f32 v64, v64, v88
    v_add_f32 v64, v64, v89
    v_add_f32 v64, v64, v90
    v_add_f32 v64, v64, v91
    v_add_f32 v64, v64, v92
    v_add_f32 v64, v64, v93
    v_add_f32 v64, v64, v94
    v_add_f32 v64, v64, v95
    v_cvt_pk_bf16_f32 v64, v64, v64
    v_lshrrev_b32 v9, 6, v0
    v_mul_u32_u24 v9, 15360, v9
    v_and_b32 v11, 63, v0
    v_lshlrev_b32 v11, 1, v11
    s_lshl_b32 s22, s2, 7
    v_add3_u32 v9, v9, v11, s22
    buffer_store_short v64, v9, s[28:31], 0 offen offset:0
LA_end:
    s_endpgm
.globl attn_kernel
.p2align 8
.type attn_kernel,@function
attn_kernel:
    s_cmp_ge_u32 s2, 512
    s_cbranch_scc1 LB_end
    s_load_dwordx4 s[20:23], s[0:1], 8
    s_load_dwordx2 s[24:25], s[0:1], 88
    v_mov_b32 v211, v0
    v_and_b32 v212, 63, v0
    v_lshrrev_b32 v196, 6, v0
    s_nop 0
    v_readfirstlane_b32 s26, v196
    v_and_b32 v196, 15, v212
    v_lshrrev_b32 v197, 4, v212
    v_lshlrev_b32 v208, 9, v196
    v_lshl_add_u32 v208, v197, 4, v208
    v_lshlrev_b32 v209, 4, v212
    v_lshrrev_b32 v210, 5, v212
    v_lshlrev_b32 v210, 2, v210
    s_lshr_b32 s27, s2, 5
    s_and_b32 s28, s2, 31
    s_lshl_b32 s16, s27, 24
    s_lshl_b32 s29, s28, 19
    s_add_u32 s16, s16, s29
    s_lshl_b32 s29, s26, 17
    s_add_u32 s16, s16, s29
    s_add_u32 s18, s16, 4096
    s_mov_b32 s19, 0x3db8aa3b
    s_waitcnt lgkmcnt(0)
    s_mov_b32 s4, s20
    s_and_b32 s5, s21, 0xffff
    s_mov_b32 s6, 268435456
    s_mov_b32 s7, 0x20000
    s_mov_b32 s8, s22
    s_and_b32 s9, s23, 0xffff
    s_mov_b32 s10, 268435456
    s_mov_b32 s11, 0x20000
    s_mov_b32 s12, s24
    s_and_b32 s13, s25, 0xffff
    s_mov_b32 s14, 1073741824
    s_mov_b32 s15, 0x20000
    s_lshr_b32 s29, s27, 3
    s_mul_i32 s29, s29, 15360
    s_and_b32 s30, s27, 7
    s_lshl_b32 s30, s30, 10
    s_add_u32 s29, s29, s30
    v_mov_b32 v198, 0x7fffff00
    v_cmp_gt_u32 vcc, 2, v196
    s_nop 1
    v_cndmask_b32 v198, v198, v208, vcc
    buffer_load_dwordx4 v[0:3], v198, s[12:15], s29 offen offset:0
    buffer_load_dwordx4 v[4:7], v198, s[12:15], s29 offen offset:64
    buffer_load_dwordx4 v[8:11], v198, s[12:15], s29 offen offset:128
    buffer_load_dwordx4 v[12:15], v198, s[12:15], s29 offen offset:192
    buffer_load_dwordx4 v[16:19], v198, s[12:15], s29 offen offset:256
    buffer_load_dwordx4 v[20:23], v198, s[12:15], s29 offen offset:320
    buffer_load_dwordx4 v[24:27], v198, s[12:15], s29 offen offset:384
    buffer_load_dwordx4 v[28:31], v198, s[12:15], s29 offen offset:448
    buffer_load_dwordx4 v[32:35], v208, s[4:7], s16 offen offset:0 nt
    buffer_load_dwordx4 v[36:39], v208, s[4:7], s16 offen offset:64 nt
    buffer_load_dwordx4 v[40:43], v208, s[4:7], s16 offen offset:128 nt
    buffer_load_dwordx4 v[44:47], v208, s[4:7], s16 offen offset:192 nt
    buffer_load_dwordx4 v[48:51], v208, s[4:7], s16 offen offset:256 nt
    buffer_load_dwordx4 v[52:55], v208, s[4:7], s16 offen offset:320 nt
    buffer_load_dwordx4 v[56:59], v208, s[4:7], s16 offen offset:384 nt
    buffer_load_dwordx4 v[60:63], v208, s[4:7], s16 offen offset:448 nt
    buffer_load_dwordx4 v[96:99], v209, s[8:11], s16 offen offset:0 nt
    buffer_load_dwordx4 v[100:103], v209, s[8:11], s16 offen offset:1024 nt
    buffer_load_dwordx4 v[104:107], v209, s[8:11], s16 offen offset:2048 nt
    buffer_load_dwordx4 v[108:111], v209, s[8:11], s16 offen offset:3072 nt
    buffer_load_dwordx4 v[112:115], v209, s[8:11], s18 offen offset:0 nt
    buffer_load_dwordx4 v[116:119], v209, s[8:11], s18 offen offset:1024 nt
    buffer_load_dwordx4 v[120:123], v209, s[8:11], s18 offen offset:2048 nt
    buffer_load_dwordx4 v[124:127], v209, s[8:11], s18 offen offset:3072 nt
    s_add_u32 s16, s16, 8192
    s_add_u32 s18, s18, 8192
    v_mov_b32 v160, 0
    v_mov_b32 v161, 0
    v_mov_b32 v162, 0
    v_mov_b32 v163, 0
    v_mov_b32 v164, 0
    v_mov_b32 v165, 0
    v_mov_b32 v166, 0
    v_mov_b32 v167, 0
    v_mov_b32 v168, 0
    v_mov_b32 v169, 0
    v_mov_b32 v170, 0
    v_mov_b32 v171, 0
    v_mov_b32 v172, 0
    v_mov_b32 v173, 0
    v_mov_b32 v174, 0
    v_mov_b32 v175, 0
    v_mov_b32 v200, 0xff800000
    v_mov_b32 v201, 0xff800000
    v_mov_b32 v202, 0
    v_mov_b32 v203, 0
    s_mov_b32 s17, 0
LB_loop:
    buffer_load_dwordx4 v[64:67], v208, s[4:7], s16 offen offset:0 nt
    buffer_load_dwordx4 v[68:71], v208, s[4:7], s16 offen offset:64 nt
    buffer_load_dwordx4 v[72:75], v208, s[4:7], s16 offen offset:128 nt
    buffer_load_dwordx4 v[76:79], v208, s[4:7], s16 offen offset:192 nt
    buffer_load_dwordx4 v[80:83], v208, s[4:7], s16 offen offset:256 nt
    buffer_load_dwordx4 v[84:87], v208, s[4:7], s16 offen offset:320 nt
    buffer_load_dwordx4 v[88:91], v208, s[4:7], s16 offen offset:384 nt
    buffer_load_dwordx4 v[92:95], v208, s[4:7], s16 offen offset:448 nt
    buffer_load_dwordx4 v[128:131], v209, s[8:11], s16 offen offset:0 nt
    buffer_load_dwordx4 v[132:135], v209, s[8:11], s16 offen offset:1024 nt
    buffer_load_dwordx4 v[136:139], v209, s[8:11], s16 offen offset:2048 nt
    buffer_load_dwordx4 v[140:143], v209, s[8:11], s16 offen offset:3072 nt
    buffer_load_dwordx4 v[144:147], v209, s[8:11], s18 offen offset:0 nt
    buffer_load_dwordx4 v[148:151], v209, s[8:11], s18 offen offset:1024 nt
    buffer_load_dwordx4 v[152:155], v209, s[8:11], s18 offen offset:2048 nt
    buffer_load_dwordx4 v[156:159], v209, s[8:11], s18 offen offset:3072 nt
    s_add_u32 s16, s16, 8192
    s_add_u32 s18, s18, 8192
    s_waitcnt vmcnt(24)
    v_mfma_f32_16x16x32_bf16 v[176:179], v[0:3], v[32:35], 0
    v_mfma_f32_16x16x32_bf16 v[176:179], v[4:7], v[36:39], v[176:179]
    v_mfma_f32_16x16x32_bf16 v[176:179], v[8:11], v[40:43], v[176:179]
    v_mfma_f32_16x16x32_bf16 v[176:179], v[12:15], v[44:47], v[176:179]
    v_mfma_f32_16x16x32_bf16 v[176:179], v[16:19], v[48:51], v[176:179]
    v_mfma_f32_16x16x32_bf16 v[176:179], v[20:23], v[52:55], v[176:179]
    v_mfma_f32_16x16x32_bf16 v[176:179], v[24:27], v[56:59], v[176:179]
    v_mfma_f32_16x16x32_bf16 v[176:179], v[28:31], v[60:63], v[176:179]
    s_nop 7
    v_cvt_pk_bf16_f32 v196, v176, v177
    v_lshlrev_b32 v176, 16, v196
    v_and_b32 v177, 0xffff0000, v196
    v_mul_f32 v176, s19, v176
    v_mul_f32 v177, s19, v177
    v_mov_b32 v213, v176
    v_mov_b32 v214, v177
    s_nop 0
    v_max_f32_dpp v213, v213, v213 row_shr:1 row_mask:0xf bank_mask:0xf
    v_max_f32_dpp v214, v214, v214 row_shr:1 row_mask:0xf bank_mask:0xf
    s_nop 0
    v_max_f32_dpp v213, v213, v213 row_shr:2 row_mask:0xf bank_mask:0xf
    v_max_f32_dpp v214, v214, v214 row_shr:2 row_mask:0xf bank_mask:0xf
    s_nop 0
    v_max_f32_dpp v213, v213, v213 row_shr:4 row_mask:0xf bank_mask:0xf
    v_max_f32_dpp v214, v214, v214 row_shr:4 row_mask:0xf bank_mask:0xf
    s_nop 0
    v_max_f32_dpp v213, v213, v213 row_shr:8 row_mask:0xf bank_mask:0xf
    v_max_f32_dpp v214, v214, v214 row_shr:8 row_mask:0xf bank_mask:0xf
    s_nop 0
    v_readlane_b32 s30, v213, 15
    v_readlane_b32 s31, v214, 15
    s_nop 1
    v_max_f32 v213, s30, v200
    v_max_f32 v214, s31, v201
    v_sub_f32 v204, v200, v213
    v_sub_f32 v205, v201, v214
    v_sub_f32 v206, v176, v213
    v_sub_f32 v207, v177, v214
    v_exp_f32 v204, v204
    v_exp_f32 v205, v205
    v_exp_f32 v206, v206
    v_exp_f32 v207, v207
    v_mov_b32 v200, v213
    v_mov_b32 v201, v214
    ds_bpermute_b32 v180, v210, v206 offset:0
    ds_bpermute_b32 v181, v210, v207 offset:0
    ds_bpermute_b32 v182, v210, v206 offset:8
    ds_bpermute_b32 v183, v210, v207 offset:8
    ds_bpermute_b32 v184, v210, v206 offset:16
    ds_bpermute_b32 v185, v210, v207 offset:16
    ds_bpermute_b32 v186, v210, v206 offset:24
    ds_bpermute_b32 v187, v210, v207 offset:24
    ds_bpermute_b32 v188, v210, v206 offset:32
    ds_bpermute_b32 v189, v210, v207 offset:32
    ds_bpermute_b32 v190, v210, v206 offset:40
    ds_bpermute_b32 v191, v210, v207 offset:40
    ds_bpermute_b32 v192, v210, v206 offset:48
    ds_bpermute_b32 v193, v210, v207 offset:48
    ds_bpermute_b32 v194, v210, v206 offset:56
    ds_bpermute_b32 v195, v210, v207 offset:56
    v_fma_f32 v202, v202, v204, v206
    v_fma_f32 v203, v203, v205, v207
    v_mul_f32 v160, v204, v160
    v_mul_f32 v168, v205, v168
    v_mul_f32 v161, v204, v161
    v_mul_f32 v169, v205, v169
    v_mul_f32 v162, v204, v162
    v_mul_f32 v170, v205, v170
    v_mul_f32 v163, v204, v163
    v_mul_f32 v171, v205, v171
    v_mul_f32 v164, v204, v164
    v_mul_f32 v172, v205, v172
    v_mul_f32 v165, v204, v165
    v_mul_f32 v173, v205, v173
    v_mul_f32 v166, v204, v166
    v_mul_f32 v174, v205, v174
    v_mul_f32 v167, v204, v167
    v_mul_f32 v175, v205, v175
    s_waitcnt vmcnt(16) lgkmcnt(0)
    v_lshlrev_b32 v196, 16, v96
    v_and_b32 v197, 0xffff0000, v96
    v_fmac_f32 v160, v180, v196
    v_fmac_f32 v161, v180, v197
    v_fmac_f32 v168, v181, v196
    v_fmac_f32 v169, v181, v197
    v_lshlrev_b32 v196, 16, v97
    v_and_b32 v197, 0xffff0000, v97
    v_fmac_f32 v162, v180, v196
    v_fmac_f32 v163, v180, v197
    v_fmac_f32 v170, v181, v196
    v_fmac_f32 v171, v181, v197
    v_lshlrev_b32 v196, 16, v98
    v_and_b32 v197, 0xffff0000, v98
    v_fmac_f32 v164, v180, v196
    v_fmac_f32 v165, v180, v197
    v_fmac_f32 v172, v181, v196
    v_fmac_f32 v173, v181, v197
    v_lshlrev_b32 v196, 16, v99
    v_and_b32 v197, 0xffff0000, v99
    v_fmac_f32 v166, v180, v196
    v_fmac_f32 v167, v180, v197
    v_fmac_f32 v174, v181, v196
    v_fmac_f32 v175, v181, v197
    v_lshlrev_b32 v196, 16, v100
    v_and_b32 v197, 0xffff0000, v100
    v_fmac_f32 v160, v182, v196
    v_fmac_f32 v161, v182, v197
    v_fmac_f32 v168, v183, v196
    v_fmac_f32 v169, v183, v197
    v_lshlrev_b32 v196, 16, v101
    v_and_b32 v197, 0xffff0000, v101
    v_fmac_f32 v162, v182, v196
    v_fmac_f32 v163, v182, v197
    v_fmac_f32 v170, v183, v196
    v_fmac_f32 v171, v183, v197
    v_lshlrev_b32 v196, 16, v102
    v_and_b32 v197, 0xffff0000, v102
    v_fmac_f32 v164, v182, v196
    v_fmac_f32 v165, v182, v197
    v_fmac_f32 v172, v183, v196
    v_fmac_f32 v173, v183, v197
    v_lshlrev_b32 v196, 16, v103
    v_and_b32 v197, 0xffff0000, v103
    v_fmac_f32 v166, v182, v196
    v_fmac_f32 v167, v182, v197
    v_fmac_f32 v174, v183, v196
    v_fmac_f32 v175, v183, v197
    v_lshlrev_b32 v196, 16, v104
    v_and_b32 v197, 0xffff0000, v104
    v_fmac_f32 v160, v184, v196
    v_fmac_f32 v161, v184, v197
    v_fmac_f32 v168, v185, v196
    v_fmac_f32 v169, v185, v197
    v_lshlrev_b32 v196, 16, v105
    v_and_b32 v197, 0xffff0000, v105
    v_fmac_f32 v162, v184, v196
    v_fmac_f32 v163, v184, v197
    v_fmac_f32 v170, v185, v196
    v_fmac_f32 v171, v185, v197
    v_lshlrev_b32 v196, 16, v106
    v_and_b32 v197, 0xffff0000, v106
    v_fmac_f32 v164, v184, v196
    v_fmac_f32 v165, v184, v197
    v_fmac_f32 v172, v185, v196
    v_fmac_f32 v173, v185, v197
    v_lshlrev_b32 v196, 16, v107
    v_and_b32 v197, 0xffff0000, v107
    v_fmac_f32 v166, v184, v196
    v_fmac_f32 v167, v184, v197
    v_fmac_f32 v174, v185, v196
    v_fmac_f32 v175, v185, v197
    v_lshlrev_b32 v196, 16, v108
    v_and_b32 v197, 0xffff0000, v108
    v_fmac_f32 v160, v186, v196
    v_fmac_f32 v161, v186, v197
    v_fmac_f32 v168, v187, v196
    v_fmac_f32 v169, v187, v197
    v_lshlrev_b32 v196, 16, v109
    v_and_b32 v197, 0xffff0000, v109
    v_fmac_f32 v162, v186, v196
    v_fmac_f32 v163, v186, v197
    v_fmac_f32 v170, v187, v196
    v_fmac_f32 v171, v187, v197
    v_lshlrev_b32 v196, 16, v110
    v_and_b32 v197, 0xffff0000, v110
    v_fmac_f32 v164, v186, v196
    v_fmac_f32 v165, v186, v197
    v_fmac_f32 v172, v187, v196
    v_fmac_f32 v173, v187, v197
    v_lshlrev_b32 v196, 16, v111
    v_and_b32 v197, 0xffff0000, v111
    v_fmac_f32 v166, v186, v196
    v_fmac_f32 v167, v186, v197
    v_fmac_f32 v174, v187, v196
    v_fmac_f32 v175, v187, v197
    v_lshlrev_b32 v196, 16, v112
    v_and_b32 v197, 0xffff0000, v112
    v_fmac_f32 v160, v188, v196
    v_fmac_f32 v161, v188, v197
    v_fmac_f32 v168, v189, v196
    v_fmac_f32 v169, v189, v197
    v_lshlrev_b32 v196, 16, v113
    v_and_b32 v197, 0xffff0000, v113
    v_fmac_f32 v162, v188, v196
    v_fmac_f32 v163, v188, v197
    v_fmac_f32 v170, v189, v196
    v_fmac_f32 v171, v189, v197
    v_lshlrev_b32 v196, 16, v114
    v_and_b32 v197, 0xffff0000, v114
    v_fmac_f32 v164, v188, v196
    v_fmac_f32 v165, v188, v197
    v_fmac_f32 v172, v189, v196
    v_fmac_f32 v173, v189, v197
    v_lshlrev_b32 v196, 16, v115
    v_and_b32 v197, 0xffff0000, v115
    v_fmac_f32 v166, v188, v196
    v_fmac_f32 v167, v188, v197
    v_fmac_f32 v174, v189, v196
    v_fmac_f32 v175, v189, v197
    v_lshlrev_b32 v196, 16, v116
    v_and_b32 v197, 0xffff0000, v116
    v_fmac_f32 v160, v190, v196
    v_fmac_f32 v161, v190, v197
    v_fmac_f32 v168, v191, v196
    v_fmac_f32 v169, v191, v197
    v_lshlrev_b32 v196, 16, v117
    v_and_b32 v197, 0xffff0000, v117
    v_fmac_f32 v162, v190, v196
    v_fmac_f32 v163, v190, v197
    v_fmac_f32 v170, v191, v196
    v_fmac_f32 v171, v191, v197
    v_lshlrev_b32 v196, 16, v118
    v_and_b32 v197, 0xffff0000, v118
    v_fmac_f32 v164, v190, v196
    v_fmac_f32 v165, v190, v197
    v_fmac_f32 v172, v191, v196
    v_fmac_f32 v173, v191, v197
    v_lshlrev_b32 v196, 16, v119
    v_and_b32 v197, 0xffff0000, v119
    v_fmac_f32 v166, v190, v196
    v_fmac_f32 v167, v190, v197
    v_fmac_f32 v174, v191, v196
    v_fmac_f32 v175, v191, v197
    v_lshlrev_b32 v196, 16, v120
    v_and_b32 v197, 0xffff0000, v120
    v_fmac_f32 v160, v192, v196
    v_fmac_f32 v161, v192, v197
    v_fmac_f32 v168, v193, v196
    v_fmac_f32 v169, v193, v197
    v_lshlrev_b32 v196, 16, v121
    v_and_b32 v197, 0xffff0000, v121
    v_fmac_f32 v162, v192, v196
    v_fmac_f32 v163, v192, v197
    v_fmac_f32 v170, v193, v196
    v_fmac_f32 v171, v193, v197
    v_lshlrev_b32 v196, 16, v122
    v_and_b32 v197, 0xffff0000, v122
    v_fmac_f32 v164, v192, v196
    v_fmac_f32 v165, v192, v197
    v_fmac_f32 v172, v193, v196
    v_fmac_f32 v173, v193, v197
    v_lshlrev_b32 v196, 16, v123
    v_and_b32 v197, 0xffff0000, v123
    v_fmac_f32 v166, v192, v196
    v_fmac_f32 v167, v192, v197
    v_fmac_f32 v174, v193, v196
    v_fmac_f32 v175, v193, v197
    v_lshlrev_b32 v196, 16, v124
    v_and_b32 v197, 0xffff0000, v124
    v_fmac_f32 v160, v194, v196
    v_fmac_f32 v161, v194, v197
    v_fmac_f32 v168, v195, v196
    v_fmac_f32 v169, v195, v197
    v_lshlrev_b32 v196, 16, v125
    v_and_b32 v197, 0xffff0000, v125
    v_fmac_f32 v162, v194, v196
    v_fmac_f32 v163, v194, v197
    v_fmac_f32 v170, v195, v196
    v_fmac_f32 v171, v195, v197
    v_lshlrev_b32 v196, 16, v126
    v_and_b32 v197, 0xffff0000, v126
    v_fmac_f32 v164, v194, v196
    v_fmac_f32 v165, v194, v197
    v_fmac_f32 v172, v195, v196
    v_fmac_f32 v173, v195, v197
    v_lshlrev_b32 v196, 16, v127
    v_and_b32 v197, 0xffff0000, v127
    v_fmac_f32 v166, v194, v196
    v_fmac_f32 v167, v194, v197
    v_fmac_f32 v174, v195, v196
    v_fmac_f32 v175, v195, v197
    buffer_load_dwordx4 v[32:35], v208, s[4:7], s16 offen offset:0 nt
    buffer_load_dwordx4 v[36:39], v208, s[4:7], s16 offen offset:64 nt
    buffer_load_dwordx4 v[40:43], v208, s[4:7], s16 offen offset:128 nt
    buffer_load_dwordx4 v[44:47], v208, s[4:7], s16 offen offset:192 nt
    buffer_load_dwordx4 v[48:51], v208, s[4:7], s16 offen offset:256 nt
    buffer_load_dwordx4 v[52:55], v208, s[4:7], s16 offen offset:320 nt
    buffer_load_dwordx4 v[56:59], v208, s[4:7], s16 offen offset:384 nt
    buffer_load_dwordx4 v[60:63], v208, s[4:7], s16 offen offset:448 nt
    buffer_load_dwordx4 v[96:99], v209, s[8:11], s16 offen offset:0 nt
    buffer_load_dwordx4 v[100:103], v209, s[8:11], s16 offen offset:1024 nt
    buffer_load_dwordx4 v[104:107], v209, s[8:11], s16 offen offset:2048 nt
    buffer_load_dwordx4 v[108:111], v209, s[8:11], s16 offen offset:3072 nt
    buffer_load_dwordx4 v[112:115], v209, s[8:11], s18 offen offset:0 nt
    buffer_load_dwordx4 v[116:119], v209, s[8:11], s18 offen offset:1024 nt
    buffer_load_dwordx4 v[120:123], v209, s[8:11], s18 offen offset:2048 nt
    buffer_load_dwordx4 v[124:127], v209, s[8:11], s18 offen offset:3072 nt
    s_add_u32 s16, s16, 8192
    s_add_u32 s18, s18, 8192
    s_waitcnt vmcnt(24)
    v_mfma_f32_16x16x32_bf16 v[176:179], v[0:3], v[64:67], 0
    v_mfma_f32_16x16x32_bf16 v[176:179], v[4:7], v[68:71], v[176:179]
    v_mfma_f32_16x16x32_bf16 v[176:179], v[8:11], v[72:75], v[176:179]
    v_mfma_f32_16x16x32_bf16 v[176:179], v[12:15], v[76:79], v[176:179]
    v_mfma_f32_16x16x32_bf16 v[176:179], v[16:19], v[80:83], v[176:179]
    v_mfma_f32_16x16x32_bf16 v[176:179], v[20:23], v[84:87], v[176:179]
    v_mfma_f32_16x16x32_bf16 v[176:179], v[24:27], v[88:91], v[176:179]
    v_mfma_f32_16x16x32_bf16 v[176:179], v[28:31], v[92:95], v[176:179]
    s_nop 7
    v_cvt_pk_bf16_f32 v196, v176, v177
    v_lshlrev_b32 v176, 16, v196
    v_and_b32 v177, 0xffff0000, v196
    v_mul_f32 v176, s19, v176
    v_mul_f32 v177, s19, v177
    v_mov_b32 v213, v176
    v_mov_b32 v214, v177
    s_nop 0
    v_max_f32_dpp v213, v213, v213 row_shr:1 row_mask:0xf bank_mask:0xf
    v_max_f32_dpp v214, v214, v214 row_shr:1 row_mask:0xf bank_mask:0xf
    s_nop 0
    v_max_f32_dpp v213, v213, v213 row_shr:2 row_mask:0xf bank_mask:0xf
    v_max_f32_dpp v214, v214, v214 row_shr:2 row_mask:0xf bank_mask:0xf
    s_nop 0
    v_max_f32_dpp v213, v213, v213 row_shr:4 row_mask:0xf bank_mask:0xf
    v_max_f32_dpp v214, v214, v214 row_shr:4 row_mask:0xf bank_mask:0xf
    s_nop 0
    v_max_f32_dpp v213, v213, v213 row_shr:8 row_mask:0xf bank_mask:0xf
    v_max_f32_dpp v214, v214, v214 row_shr:8 row_mask:0xf bank_mask:0xf
    s_nop 0
    v_readlane_b32 s30, v213, 15
    v_readlane_b32 s31, v214, 15
    s_nop 1
    v_max_f32 v213, s30, v200
    v_max_f32 v214, s31, v201
    v_sub_f32 v204, v200, v213
    v_sub_f32 v205, v201, v214
    v_sub_f32 v206, v176, v213
    v_sub_f32 v207, v177, v214
    v_exp_f32 v204, v204
    v_exp_f32 v205, v205
    v_exp_f32 v206, v206
    v_exp_f32 v207, v207
    v_mov_b32 v200, v213
    v_mov_b32 v201, v214
    ds_bpermute_b32 v180, v210, v206 offset:0
    ds_bpermute_b32 v181, v210, v207 offset:0
    ds_bpermute_b32 v182, v210, v206 offset:8
    ds_bpermute_b32 v183, v210, v207 offset:8
    ds_bpermute_b32 v184, v210, v206 offset:16
    ds_bpermute_b32 v185, v210, v207 offset:16
    ds_bpermute_b32 v186, v210, v206 offset:24
    ds_bpermute_b32 v187, v210, v207 offset:24
    ds_bpermute_b32 v188, v210, v206 offset:32
    ds_bpermute_b32 v189, v210, v207 offset:32
    ds_bpermute_b32 v190, v210, v206 offset:40
    ds_bpermute_b32 v191, v210, v207 offset:40
    ds_bpermute_b32 v192, v210, v206 offset:48
    ds_bpermute_b32 v193, v210, v207 offset:48
    ds_bpermute_b32 v194, v210, v206 offset:56
    ds_bpermute_b32 v195, v210, v207 offset:56
    v_fma_f32 v202, v202, v204, v206
    v_fma_f32 v203, v203, v205, v207
    v_mul_f32 v160, v204, v160
    v_mul_f32 v168, v205, v168
    v_mul_f32 v161, v204, v161
    v_mul_f32 v169, v205, v169
    v_mul_f32 v162, v204, v162
    v_mul_f32 v170, v205, v170
    v_mul_f32 v163, v204, v163
    v_mul_f32 v171, v205, v171
    v_mul_f32 v164, v204, v164
    v_mul_f32 v172, v205, v172
    v_mul_f32 v165, v204, v165
    v_mul_f32 v173, v205, v173
    v_mul_f32 v166, v204, v166
    v_mul_f32 v174, v205, v174
    v_mul_f32 v167, v204, v167
    v_mul_f32 v175, v205, v175
    s_waitcnt vmcnt(16) lgkmcnt(0)
    v_lshlrev_b32 v196, 16, v128
    v_and_b32 v197, 0xffff0000, v128
    v_fmac_f32 v160, v180, v196
    v_fmac_f32 v161, v180, v197
    v_fmac_f32 v168, v181, v196
    v_fmac_f32 v169, v181, v197
    v_lshlrev_b32 v196, 16, v129
    v_and_b32 v197, 0xffff0000, v129
    v_fmac_f32 v162, v180, v196
    v_fmac_f32 v163, v180, v197
    v_fmac_f32 v170, v181, v196
    v_fmac_f32 v171, v181, v197
    v_lshlrev_b32 v196, 16, v130
    v_and_b32 v197, 0xffff0000, v130
    v_fmac_f32 v164, v180, v196
    v_fmac_f32 v165, v180, v197
    v_fmac_f32 v172, v181, v196
    v_fmac_f32 v173, v181, v197
    v_lshlrev_b32 v196, 16, v131
    v_and_b32 v197, 0xffff0000, v131
    v_fmac_f32 v166, v180, v196
    v_fmac_f32 v167, v180, v197
    v_fmac_f32 v174, v181, v196
    v_fmac_f32 v175, v181, v197
    v_lshlrev_b32 v196, 16, v132
    v_and_b32 v197, 0xffff0000, v132
    v_fmac_f32 v160, v182, v196
    v_fmac_f32 v161, v182, v197
    v_fmac_f32 v168, v183, v196
    v_fmac_f32 v169, v183, v197
    v_lshlrev_b32 v196, 16, v133
    v_and_b32 v197, 0xffff0000, v133
    v_fmac_f32 v162, v182, v196
    v_fmac_f32 v163, v182, v197
    v_fmac_f32 v170, v183, v196
    v_fmac_f32 v171, v183, v197
    v_lshlrev_b32 v196, 16, v134
    v_and_b32 v197, 0xffff0000, v134
    v_fmac_f32 v164, v182, v196
    v_fmac_f32 v165, v182, v197
    v_fmac_f32 v172, v183, v196
    v_fmac_f32 v173, v183, v197
    v_lshlrev_b32 v196, 16, v135
    v_and_b32 v197, 0xffff0000, v135
    v_fmac_f32 v166, v182, v196
    v_fmac_f32 v167, v182, v197
    v_fmac_f32 v174, v183, v196
    v_fmac_f32 v175, v183, v197
    v_lshlrev_b32 v196, 16, v136
    v_and_b32 v197, 0xffff0000, v136
    v_fmac_f32 v160, v184, v196
    v_fmac_f32 v161, v184, v197
    v_fmac_f32 v168, v185, v196
    v_fmac_f32 v169, v185, v197
    v_lshlrev_b32 v196, 16, v137
    v_and_b32 v197, 0xffff0000, v137
    v_fmac_f32 v162, v184, v196
    v_fmac_f32 v163, v184, v197
    v_fmac_f32 v170, v185, v196
    v_fmac_f32 v171, v185, v197
    v_lshlrev_b32 v196, 16, v138
    v_and_b32 v197, 0xffff0000, v138
    v_fmac_f32 v164, v184, v196
    v_fmac_f32 v165, v184, v197
    v_fmac_f32 v172, v185, v196
    v_fmac_f32 v173, v185, v197
    v_lshlrev_b32 v196, 16, v139
    v_and_b32 v197, 0xffff0000, v139
    v_fmac_f32 v166, v184, v196
    v_fmac_f32 v167, v184, v197
    v_fmac_f32 v174, v185, v196
    v_fmac_f32 v175, v185, v197
    v_lshlrev_b32 v196, 16, v140
    v_and_b32 v197, 0xffff0000, v140
    v_fmac_f32 v160, v186, v196
    v_fmac_f32 v161, v186, v197
    v_fmac_f32 v168, v187, v196
    v_fmac_f32 v169, v187, v197
    v_lshlrev_b32 v196, 16, v141
    v_and_b32 v197, 0xffff0000, v141
    v_fmac_f32 v162, v186, v196
    v_fmac_f32 v163, v186, v197
    v_fmac_f32 v170, v187, v196
    v_fmac_f32 v171, v187, v197
    v_lshlrev_b32 v196, 16, v142
    v_and_b32 v197, 0xffff0000, v142
    v_fmac_f32 v164, v186, v196
    v_fmac_f32 v165, v186, v197
    v_fmac_f32 v172, v187, v196
    v_fmac_f32 v173, v187, v197
    v_lshlrev_b32 v196, 16, v143
    v_and_b32 v197, 0xffff0000, v143
    v_fmac_f32 v166, v186, v196
    v_fmac_f32 v167, v186, v197
    v_fmac_f32 v174, v187, v196
    v_fmac_f32 v175, v187, v197
    v_lshlrev_b32 v196, 16, v144
    v_and_b32 v197, 0xffff0000, v144
    v_fmac_f32 v160, v188, v196
    v_fmac_f32 v161, v188, v197
    v_fmac_f32 v168, v189, v196
    v_fmac_f32 v169, v189, v197
    v_lshlrev_b32 v196, 16, v145
    v_and_b32 v197, 0xffff0000, v145
    v_fmac_f32 v162, v188, v196
    v_fmac_f32 v163, v188, v197
    v_fmac_f32 v170, v189, v196
    v_fmac_f32 v171, v189, v197
    v_lshlrev_b32 v196, 16, v146
    v_and_b32 v197, 0xffff0000, v146
    v_fmac_f32 v164, v188, v196
    v_fmac_f32 v165, v188, v197
    v_fmac_f32 v172, v189, v196
    v_fmac_f32 v173, v189, v197
    v_lshlrev_b32 v196, 16, v147
    v_and_b32 v197, 0xffff0000, v147
    v_fmac_f32 v166, v188, v196
    v_fmac_f32 v167, v188, v197
    v_fmac_f32 v174, v189, v196
    v_fmac_f32 v175, v189, v197
    v_lshlrev_b32 v196, 16, v148
    v_and_b32 v197, 0xffff0000, v148
    v_fmac_f32 v160, v190, v196
    v_fmac_f32 v161, v190, v197
    v_fmac_f32 v168, v191, v196
    v_fmac_f32 v169, v191, v197
    v_lshlrev_b32 v196, 16, v149
    v_and_b32 v197, 0xffff0000, v149
    v_fmac_f32 v162, v190, v196
    v_fmac_f32 v163, v190, v197
    v_fmac_f32 v170, v191, v196
    v_fmac_f32 v171, v191, v197
    v_lshlrev_b32 v196, 16, v150
    v_and_b32 v197, 0xffff0000, v150
    v_fmac_f32 v164, v190, v196
    v_fmac_f32 v165, v190, v197
    v_fmac_f32 v172, v191, v196
    v_fmac_f32 v173, v191, v197
    v_lshlrev_b32 v196, 16, v151
    v_and_b32 v197, 0xffff0000, v151
    v_fmac_f32 v166, v190, v196
    v_fmac_f32 v167, v190, v197
    v_fmac_f32 v174, v191, v196
    v_fmac_f32 v175, v191, v197
    v_lshlrev_b32 v196, 16, v152
    v_and_b32 v197, 0xffff0000, v152
    v_fmac_f32 v160, v192, v196
    v_fmac_f32 v161, v192, v197
    v_fmac_f32 v168, v193, v196
    v_fmac_f32 v169, v193, v197
    v_lshlrev_b32 v196, 16, v153
    v_and_b32 v197, 0xffff0000, v153
    v_fmac_f32 v162, v192, v196
    v_fmac_f32 v163, v192, v197
    v_fmac_f32 v170, v193, v196
    v_fmac_f32 v171, v193, v197
    v_lshlrev_b32 v196, 16, v154
    v_and_b32 v197, 0xffff0000, v154
    v_fmac_f32 v164, v192, v196
    v_fmac_f32 v165, v192, v197
    v_fmac_f32 v172, v193, v196
    v_fmac_f32 v173, v193, v197
    v_lshlrev_b32 v196, 16, v155
    v_and_b32 v197, 0xffff0000, v155
    v_fmac_f32 v166, v192, v196
    v_fmac_f32 v167, v192, v197
    v_fmac_f32 v174, v193, v196
    v_fmac_f32 v175, v193, v197
    v_lshlrev_b32 v196, 16, v156
    v_and_b32 v197, 0xffff0000, v156
    v_fmac_f32 v160, v194, v196
    v_fmac_f32 v161, v194, v197
    v_fmac_f32 v168, v195, v196
    v_fmac_f32 v169, v195, v197
    v_lshlrev_b32 v196, 16, v157
    v_and_b32 v197, 0xffff0000, v157
    v_fmac_f32 v162, v194, v196
    v_fmac_f32 v163, v194, v197
    v_fmac_f32 v170, v195, v196
    v_fmac_f32 v171, v195, v197
    v_lshlrev_b32 v196, 16, v158
    v_and_b32 v197, 0xffff0000, v158
    v_fmac_f32 v164, v194, v196
    v_fmac_f32 v165, v194, v197
    v_fmac_f32 v172, v195, v196
    v_fmac_f32 v173, v195, v197
    v_lshlrev_b32 v196, 16, v159
    v_and_b32 v197, 0xffff0000, v159
    v_fmac_f32 v166, v194, v196
    v_fmac_f32 v167, v194, v197
    v_fmac_f32 v174, v195, v196
    v_fmac_f32 v175, v195, v197
    s_add_u32 s17, s17, 1
    s_cmp_lt_u32 s17, 7
    s_cbranch_scc1 LB_loop
    buffer_load_dwordx4 v[64:67], v208, s[4:7], s16 offen offset:0 nt
    buffer_load_dwordx4 v[68:71], v208, s[4:7], s16 offen offset:64 nt
    buffer_load_dwordx4 v[72:75], v208, s[4:7], s16 offen offset:128 nt
    buffer_load_dwordx4 v[76:79], v208, s[4:7], s16 offen offset:192 nt
    buffer_load_dwordx4 v[80:83], v208, s[4:7], s16 offen offset:256 nt
    buffer_load_dwordx4 v[84:87], v208, s[4:7], s16 offen offset:320 nt
    buffer_load_dwordx4 v[88:91], v208, s[4:7], s16 offen offset:384 nt
    buffer_load_dwordx4 v[92:95], v208, s[4:7], s16 offen offset:448 nt
    buffer_load_dwordx4 v[128:131], v209, s[8:11], s16 offen offset:0 nt
    buffer_load_dwordx4 v[132:135], v209, s[8:11], s16 offen offset:1024 nt
    buffer_load_dwordx4 v[136:139], v209, s[8:11], s16 offen offset:2048 nt
    buffer_load_dwordx4 v[140:143], v209, s[8:11], s16 offen offset:3072 nt
    buffer_load_dwordx4 v[144:147], v209, s[8:11], s18 offen offset:0 nt
    buffer_load_dwordx4 v[148:151], v209, s[8:11], s18 offen offset:1024 nt
    buffer_load_dwordx4 v[152:155], v209, s[8:11], s18 offen offset:2048 nt
    buffer_load_dwordx4 v[156:159], v209, s[8:11], s18 offen offset:3072 nt
    s_add_u32 s16, s16, 8192
    s_add_u32 s18, s18, 8192
    s_waitcnt vmcnt(24)
    v_mfma_f32_16x16x32_bf16 v[176:179], v[0:3], v[32:35], 0
    v_mfma_f32_16x16x32_bf16 v[176:179], v[4:7], v[36:39], v[176:179]
    v_mfma_f32_16x16x32_bf16 v[176:179], v[8:11], v[40:43], v[176:179]
    v_mfma_f32_16x16x32_bf16 v[176:179], v[12:15], v[44:47], v[176:179]
    v_mfma_f32_16x16x32_bf16 v[176:179], v[16:19], v[48:51], v[176:179]
    v_mfma_f32_16x16x32_bf16 v[176:179], v[20:23], v[52:55], v[176:179]
    v_mfma_f32_16x16x32_bf16 v[176:179], v[24:27], v[56:59], v[176:179]
    v_mfma_f32_16x16x32_bf16 v[176:179], v[28:31], v[60:63], v[176:179]
    s_nop 7
    v_cvt_pk_bf16_f32 v196, v176, v177
    v_lshlrev_b32 v176, 16, v196
    v_and_b32 v177, 0xffff0000, v196
    v_mul_f32 v176, s19, v176
    v_mul_f32 v177, s19, v177
    v_mov_b32 v213, v176
    v_mov_b32 v214, v177
    s_nop 0
    v_max_f32_dpp v213, v213, v213 row_shr:1 row_mask:0xf bank_mask:0xf
    v_max_f32_dpp v214, v214, v214 row_shr:1 row_mask:0xf bank_mask:0xf
    s_nop 0
    v_max_f32_dpp v213, v213, v213 row_shr:2 row_mask:0xf bank_mask:0xf
    v_max_f32_dpp v214, v214, v214 row_shr:2 row_mask:0xf bank_mask:0xf
    s_nop 0
    v_max_f32_dpp v213, v213, v213 row_shr:4 row_mask:0xf bank_mask:0xf
    v_max_f32_dpp v214, v214, v214 row_shr:4 row_mask:0xf bank_mask:0xf
    s_nop 0
    v_max_f32_dpp v213, v213, v213 row_shr:8 row_mask:0xf bank_mask:0xf
    v_max_f32_dpp v214, v214, v214 row_shr:8 row_mask:0xf bank_mask:0xf
    s_nop 0
    v_readlane_b32 s30, v213, 15
    v_readlane_b32 s31, v214, 15
    s_nop 1
    v_max_f32 v213, s30, v200
    v_max_f32 v214, s31, v201
    v_sub_f32 v204, v200, v213
    v_sub_f32 v205, v201, v214
    v_sub_f32 v206, v176, v213
    v_sub_f32 v207, v177, v214
    v_exp_f32 v204, v204
    v_exp_f32 v205, v205
    v_exp_f32 v206, v206
    v_exp_f32 v207, v207
    v_mov_b32 v200, v213
    v_mov_b32 v201, v214
    ds_bpermute_b32 v180, v210, v206 offset:0
    ds_bpermute_b32 v181, v210, v207 offset:0
    ds_bpermute_b32 v182, v210, v206 offset:8
    ds_bpermute_b32 v183, v210, v207 offset:8
    ds_bpermute_b32 v184, v210, v206 offset:16
    ds_bpermute_b32 v185, v210, v207 offset:16
    ds_bpermute_b32 v186, v210, v206 offset:24
    ds_bpermute_b32 v187, v210, v207 offset:24
    ds_bpermute_b32 v188, v210, v206 offset:32
    ds_bpermute_b32 v189, v210, v207 offset:32
    ds_bpermute_b32 v190, v210, v206 offset:40
    ds_bpermute_b32 v191, v210, v207 offset:40
    ds_bpermute_b32 v192, v210, v206 offset:48
    ds_bpermute_b32 v193, v210, v207 offset:48
    ds_bpermute_b32 v194, v210, v206 offset:56
    ds_bpermute_b32 v195, v210, v207 offset:56
    v_fma_f32 v202, v202, v204, v206
    v_fma_f32 v203, v203, v205, v207
    v_mul_f32 v160, v204, v160
    v_mul_f32 v168, v205, v168
    v_mul_f32 v161, v204, v161
    v_mul_f32 v169, v205, v169
    v_mul_f32 v162, v204, v162
    v_mul_f32 v170, v205, v170
    v_mul_f32 v163, v204, v163
    v_mul_f32 v171, v205, v171
    v_mul_f32 v164, v204, v164
    v_mul_f32 v172, v205, v172
    v_mul_f32 v165, v204, v165
    v_mul_f32 v173, v205, v173
    v_mul_f32 v166, v204, v166
    v_mul_f32 v174, v205, v174
    v_mul_f32 v167, v204, v167
    v_mul_f32 v175, v205, v175
    s_waitcnt vmcnt(16) lgkmcnt(0)
    v_lshlrev_b32 v196, 16, v96
    v_and_b32 v197, 0xffff0000, v96
    v_fmac_f32 v160, v180, v196
    v_fmac_f32 v161, v180, v197
    v_fmac_f32 v168, v181, v196
    v_fmac_f32 v169, v181, v197
    v_lshlrev_b32 v196, 16, v97
    v_and_b32 v197, 0xffff0000, v97
    v_fmac_f32 v162, v180, v196
    v_fmac_f32 v163, v180, v197
    v_fmac_f32 v170, v181, v196
    v_fmac_f32 v171, v181, v197
    v_lshlrev_b32 v196, 16, v98
    v_and_b32 v197, 0xffff0000, v98
    v_fmac_f32 v164, v180, v196
    v_fmac_f32 v165, v180, v197
    v_fmac_f32 v172, v181, v196
    v_fmac_f32 v173, v181, v197
    v_lshlrev_b32 v196, 16, v99
    v_and_b32 v197, 0xffff0000, v99
    v_fmac_f32 v166, v180, v196
    v_fmac_f32 v167, v180, v197
    v_fmac_f32 v174, v181, v196
    v_fmac_f32 v175, v181, v197
    v_lshlrev_b32 v196, 16, v100
    v_and_b32 v197, 0xffff0000, v100
    v_fmac_f32 v160, v182, v196
    v_fmac_f32 v161, v182, v197
    v_fmac_f32 v168, v183, v196
    v_fmac_f32 v169, v183, v197
    v_lshlrev_b32 v196, 16, v101
    v_and_b32 v197, 0xffff0000, v101
    v_fmac_f32 v162, v182, v196
    v_fmac_f32 v163, v182, v197
    v_fmac_f32 v170, v183, v196
    v_fmac_f32 v171, v183, v197
    v_lshlrev_b32 v196, 16, v102
    v_and_b32 v197, 0xffff0000, v102
    v_fmac_f32 v164, v182, v196
    v_fmac_f32 v165, v182, v197
    v_fmac_f32 v172, v183, v196
    v_fmac_f32 v173, v183, v197
    v_lshlrev_b32 v196, 16, v103
    v_and_b32 v197, 0xffff0000, v103
    v_fmac_f32 v166, v182, v196
    v_fmac_f32 v167, v182, v197
    v_fmac_f32 v174, v183, v196
    v_fmac_f32 v175, v183, v197
    v_lshlrev_b32 v196, 16, v104
    v_and_b32 v197, 0xffff0000, v104
    v_fmac_f32 v160, v184, v196
    v_fmac_f32 v161, v184, v197
    v_fmac_f32 v168, v185, v196
    v_fmac_f32 v169, v185, v197
    v_lshlrev_b32 v196, 16, v105
    v_and_b32 v197, 0xffff0000, v105
    v_fmac_f32 v162, v184, v196
    v_fmac_f32 v163, v184, v197
    v_fmac_f32 v170, v185, v196
    v_fmac_f32 v171, v185, v197
    v_lshlrev_b32 v196, 16, v106
    v_and_b32 v197, 0xffff0000, v106
    v_fmac_f32 v164, v184, v196
    v_fmac_f32 v165, v184, v197
    v_fmac_f32 v172, v185, v196
    v_fmac_f32 v173, v185, v197
    v_lshlrev_b32 v196, 16, v107
    v_and_b32 v197, 0xffff0000, v107
    v_fmac_f32 v166, v184, v196
    v_fmac_f32 v167, v184, v197
    v_fmac_f32 v174, v185, v196
    v_fmac_f32 v175, v185, v197
    v_lshlrev_b32 v196, 16, v108
    v_and_b32 v197, 0xffff0000, v108
    v_fmac_f32 v160, v186, v196
    v_fmac_f32 v161, v186, v197
    v_fmac_f32 v168, v187, v196
    v_fmac_f32 v169, v187, v197
    v_lshlrev_b32 v196, 16, v109
    v_and_b32 v197, 0xffff0000, v109
    v_fmac_f32 v162, v186, v196
    v_fmac_f32 v163, v186, v197
    v_fmac_f32 v170, v187, v196
    v_fmac_f32 v171, v187, v197
    v_lshlrev_b32 v196, 16, v110
    v_and_b32 v197, 0xffff0000, v110
    v_fmac_f32 v164, v186, v196
    v_fmac_f32 v165, v186, v197
    v_fmac_f32 v172, v187, v196
    v_fmac_f32 v173, v187, v197
    v_lshlrev_b32 v196, 16, v111
    v_and_b32 v197, 0xffff0000, v111
    v_fmac_f32 v166, v186, v196
    v_fmac_f32 v167, v186, v197
    v_fmac_f32 v174, v187, v196
    v_fmac_f32 v175, v187, v197
    v_lshlrev_b32 v196, 16, v112
    v_and_b32 v197, 0xffff0000, v112
    v_fmac_f32 v160, v188, v196
    v_fmac_f32 v161, v188, v197
    v_fmac_f32 v168, v189, v196
    v_fmac_f32 v169, v189, v197
    v_lshlrev_b32 v196, 16, v113
    v_and_b32 v197, 0xffff0000, v113
    v_fmac_f32 v162, v188, v196
    v_fmac_f32 v163, v188, v197
    v_fmac_f32 v170, v189, v196
    v_fmac_f32 v171, v189, v197
    v_lshlrev_b32 v196, 16, v114
    v_and_b32 v197, 0xffff0000, v114
    v_fmac_f32 v164, v188, v196
    v_fmac_f32 v165, v188, v197
    v_fmac_f32 v172, v189, v196
    v_fmac_f32 v173, v189, v197
    v_lshlrev_b32 v196, 16, v115
    v_and_b32 v197, 0xffff0000, v115
    v_fmac_f32 v166, v188, v196
    v_fmac_f32 v167, v188, v197
    v_fmac_f32 v174, v189, v196
    v_fmac_f32 v175, v189, v197
    v_lshlrev_b32 v196, 16, v116
    v_and_b32 v197, 0xffff0000, v116
    v_fmac_f32 v160, v190, v196
    v_fmac_f32 v161, v190, v197
    v_fmac_f32 v168, v191, v196
    v_fmac_f32 v169, v191, v197
    v_lshlrev_b32 v196, 16, v117
    v_and_b32 v197, 0xffff0000, v117
    v_fmac_f32 v162, v190, v196
    v_fmac_f32 v163, v190, v197
    v_fmac_f32 v170, v191, v196
    v_fmac_f32 v171, v191, v197
    v_lshlrev_b32 v196, 16, v118
    v_and_b32 v197, 0xffff0000, v118
    v_fmac_f32 v164, v190, v196
    v_fmac_f32 v165, v190, v197
    v_fmac_f32 v172, v191, v196
    v_fmac_f32 v173, v191, v197
    v_lshlrev_b32 v196, 16, v119
    v_and_b32 v197, 0xffff0000, v119
    v_fmac_f32 v166, v190, v196
    v_fmac_f32 v167, v190, v197
    v_fmac_f32 v174, v191, v196
    v_fmac_f32 v175, v191, v197
    v_lshlrev_b32 v196, 16, v120
    v_and_b32 v197, 0xffff0000, v120
    v_fmac_f32 v160, v192, v196
    v_fmac_f32 v161, v192, v197
    v_fmac_f32 v168, v193, v196
    v_fmac_f32 v169, v193, v197
    v_lshlrev_b32 v196, 16, v121
    v_and_b32 v197, 0xffff0000, v121
    v_fmac_f32 v162, v192, v196
    v_fmac_f32 v163, v192, v197
    v_fmac_f32 v170, v193, v196
    v_fmac_f32 v171, v193, v197
    v_lshlrev_b32 v196, 16, v122
    v_and_b32 v197, 0xffff0000, v122
    v_fmac_f32 v164, v192, v196
    v_fmac_f32 v165, v192, v197
    v_fmac_f32 v172, v193, v196
    v_fmac_f32 v173, v193, v197
    v_lshlrev_b32 v196, 16, v123
    v_and_b32 v197, 0xffff0000, v123
    v_fmac_f32 v166, v192, v196
    v_fmac_f32 v167, v192, v197
    v_fmac_f32 v174, v193, v196
    v_fmac_f32 v175, v193, v197
    v_lshlrev_b32 v196, 16, v124
    v_and_b32 v197, 0xffff0000, v124
    v_fmac_f32 v160, v194, v196
    v_fmac_f32 v161, v194, v197
    v_fmac_f32 v168, v195, v196
    v_fmac_f32 v169, v195, v197
    v_lshlrev_b32 v196, 16, v125
    v_and_b32 v197, 0xffff0000, v125
    v_fmac_f32 v162, v194, v196
    v_fmac_f32 v163, v194, v197
    v_fmac_f32 v170, v195, v196
    v_fmac_f32 v171, v195, v197
    v_lshlrev_b32 v196, 16, v126
    v_and_b32 v197, 0xffff0000, v126
    v_fmac_f32 v164, v194, v196
    v_fmac_f32 v165, v194, v197
    v_fmac_f32 v172, v195, v196
    v_fmac_f32 v173, v195, v197
    v_lshlrev_b32 v196, 16, v127
    v_and_b32 v197, 0xffff0000, v127
    v_fmac_f32 v166, v194, v196
    v_fmac_f32 v167, v194, v197
    v_fmac_f32 v174, v195, v196
    v_fmac_f32 v175, v195, v197
    s_waitcnt vmcnt(8)
    v_mfma_f32_16x16x32_bf16 v[176:179], v[0:3], v[64:67], 0
    v_mfma_f32_16x16x32_bf16 v[176:179], v[4:7], v[68:71], v[176:179]
    v_mfma_f32_16x16x32_bf16 v[176:179], v[8:11], v[72:75], v[176:179]
    v_mfma_f32_16x16x32_bf16 v[176:179], v[12:15], v[76:79], v[176:179]
    v_mfma_f32_16x16x32_bf16 v[176:179], v[16:19], v[80:83], v[176:179]
    v_mfma_f32_16x16x32_bf16 v[176:179], v[20:23], v[84:87], v[176:179]
    v_mfma_f32_16x16x32_bf16 v[176:179], v[24:27], v[88:91], v[176:179]
    v_mfma_f32_16x16x32_bf16 v[176:179], v[28:31], v[92:95], v[176:179]
    s_nop 7
    v_cvt_pk_bf16_f32 v196, v176, v177
    v_lshlrev_b32 v176, 16, v196
    v_and_b32 v177, 0xffff0000, v196
    v_mul_f32 v176, s19, v176
    v_mul_f32 v177, s19, v177
    v_mov_b32 v213, v176
    v_mov_b32 v214, v177
    s_nop 0
    v_max_f32_dpp v213, v213, v213 row_shr:1 row_mask:0xf bank_mask:0xf
    v_max_f32_dpp v214, v214, v214 row_shr:1 row_mask:0xf bank_mask:0xf
    s_nop 0
    v_max_f32_dpp v213, v213, v213 row_shr:2 row_mask:0xf bank_mask:0xf
    v_max_f32_dpp v214, v214, v214 row_shr:2 row_mask:0xf bank_mask:0xf
    s_nop 0
    v_max_f32_dpp v213, v213, v213 row_shr:4 row_mask:0xf bank_mask:0xf
    v_max_f32_dpp v214, v214, v214 row_shr:4 row_mask:0xf bank_mask:0xf
    s_nop 0
    v_max_f32_dpp v213, v213, v213 row_shr:8 row_mask:0xf bank_mask:0xf
    v_max_f32_dpp v214, v214, v214 row_shr:8 row_mask:0xf bank_mask:0xf
    s_nop 0
    v_readlane_b32 s30, v213, 15
    v_readlane_b32 s31, v214, 15
    s_nop 1
    v_max_f32 v213, s30, v200
    v_max_f32 v214, s31, v201
    v_sub_f32 v204, v200, v213
    v_sub_f32 v205, v201, v214
    v_sub_f32 v206, v176, v213
    v_sub_f32 v207, v177, v214
    v_exp_f32 v204, v204
    v_exp_f32 v205, v205
    v_exp_f32 v206, v206
    v_exp_f32 v207, v207
    v_mov_b32 v200, v213
    v_mov_b32 v201, v214
    ds_bpermute_b32 v180, v210, v206 offset:0
    ds_bpermute_b32 v181, v210, v207 offset:0
    ds_bpermute_b32 v182, v210, v206 offset:8
    ds_bpermute_b32 v183, v210, v207 offset:8
    ds_bpermute_b32 v184, v210, v206 offset:16
    ds_bpermute_b32 v185, v210, v207 offset:16
    ds_bpermute_b32 v186, v210, v206 offset:24
    ds_bpermute_b32 v187, v210, v207 offset:24
    ds_bpermute_b32 v188, v210, v206 offset:32
    ds_bpermute_b32 v189, v210, v207 offset:32
    ds_bpermute_b32 v190, v210, v206 offset:40
    ds_bpermute_b32 v191, v210, v207 offset:40
    ds_bpermute_b32 v192, v210, v206 offset:48
    ds_bpermute_b32 v193, v210, v207 offset:48
    ds_bpermute_b32 v194, v210, v206 offset:56
    ds_bpermute_b32 v195, v210, v207 offset:56
    v_fma_f32 v202, v202, v204, v206
    v_fma_f32 v203, v203, v205, v207
    v_mul_f32 v160, v204, v160
    v_mul_f32 v168, v205, v168
    v_mul_f32 v161, v204, v161
    v_mul_f32 v169, v205, v169
    v_mul_f32 v162, v204, v162
    v_mul_f32 v170, v205, v170
    v_mul_f32 v163, v204, v163
    v_mul_f32 v171, v205, v171
    v_mul_f32 v164, v204, v164
    v_mul_f32 v172, v205, v172
    v_mul_f32 v165, v204, v165
    v_mul_f32 v173, v205, v173
    v_mul_f32 v166, v204, v166
    v_mul_f32 v174, v205, v174
    v_mul_f32 v167, v204, v167
    v_mul_f32 v175, v205, v175
    s_waitcnt vmcnt(0) lgkmcnt(0)
    v_lshlrev_b32 v196, 16, v128
    v_and_b32 v197, 0xffff0000, v128
    v_fmac_f32 v160, v180, v196
    v_fmac_f32 v161, v180, v197
    v_fmac_f32 v168, v181, v196
    v_fmac_f32 v169, v181, v197
    v_lshlrev_b32 v196, 16, v129
    v_and_b32 v197, 0xffff0000, v129
    v_fmac_f32 v162, v180, v196
    v_fmac_f32 v163, v180, v197
    v_fmac_f32 v170, v181, v196
    v_fmac_f32 v171, v181, v197
    v_lshlrev_b32 v196, 16, v130
    v_and_b32 v197, 0xffff0000, v130
    v_fmac_f32 v164, v180, v196
    v_fmac_f32 v165, v180, v197
    v_fmac_f32 v172, v181, v196
    v_fmac_f32 v173, v181, v197
    v_lshlrev_b32 v196, 16, v131
    v_and_b32 v197, 0xffff0000, v131
    v_fmac_f32 v166, v180, v196
    v_fmac_f32 v167, v180, v197
    v_fmac_f32 v174, v181, v196
    v_fmac_f32 v175, v181, v197
    v_lshlrev_b32 v196, 16, v132
    v_and_b32 v197, 0xffff0000, v132
    v_fmac_f32 v160, v182, v196
    v_fmac_f32 v161, v182, v197
    v_fmac_f32 v168, v183, v196
    v_fmac_f32 v169, v183, v197
    v_lshlrev_b32 v196, 16, v133
    v_and_b32 v197, 0xffff0000, v133
    v_fmac_f32 v162, v182, v196
    v_fmac_f32 v163, v182, v197
    v_fmac_f32 v170, v183, v196
    v_fmac_f32 v171, v183, v197
    v_lshlrev_b32 v196, 16, v134
    v_and_b32 v197, 0xffff0000, v134
    v_fmac_f32 v164, v182, v196
    v_fmac_f32 v165, v182, v197
    v_fmac_f32 v172, v183, v196
    v_fmac_f32 v173, v183, v197
    v_lshlrev_b32 v196, 16, v135
    v_and_b32 v197, 0xffff0000, v135
    v_fmac_f32 v166, v182, v196
    v_fmac_f32 v167, v182, v197
    v_fmac_f32 v174, v183, v196
    v_fmac_f32 v175, v183, v197
    v_lshlrev_b32 v196, 16, v136
    v_and_b32 v197, 0xffff0000, v136
    v_fmac_f32 v160, v184, v196
    v_fmac_f32 v161, v184, v197
    v_fmac_f32 v168, v185, v196
    v_fmac_f32 v169, v185, v197
    v_lshlrev_b32 v196, 16, v137
    v_and_b32 v197, 0xffff0000, v137
    v_fmac_f32 v162, v184, v196
    v_fmac_f32 v163, v184, v197
    v_fmac_f32 v170, v185, v196
    v_fmac_f32 v171, v185, v197
    v_lshlrev_b32 v196, 16, v138
    v_and_b32 v197, 0xffff0000, v138
    v_fmac_f32 v164, v184, v196
    v_fmac_f32 v165, v184, v197
    v_fmac_f32 v172, v185, v196
    v_fmac_f32 v173, v185, v197
    v_lshlrev_b32 v196, 16, v139
    v_and_b32 v197, 0xffff0000, v139
    v_fmac_f32 v166, v184, v196
    v_fmac_f32 v167, v184, v197
    v_fmac_f32 v174, v185, v196
    v_fmac_f32 v175, v185, v197
    v_lshlrev_b32 v196, 16, v140
    v_and_b32 v197, 0xffff0000, v140
    v_fmac_f32 v160, v186, v196
    v_fmac_f32 v161, v186, v197
    v_fmac_f32 v168, v187, v196
    v_fmac_f32 v169, v187, v197
    v_lshlrev_b32 v196, 16, v141
    v_and_b32 v197, 0xffff0000, v141
    v_fmac_f32 v162, v186, v196
    v_fmac_f32 v163, v186, v197
    v_fmac_f32 v170, v187, v196
    v_fmac_f32 v171, v187, v197
    v_lshlrev_b32 v196, 16, v142
    v_and_b32 v197, 0xffff0000, v142
    v_fmac_f32 v164, v186, v196
    v_fmac_f32 v165, v186, v197
    v_fmac_f32 v172, v187, v196
    v_fmac_f32 v173, v187, v197
    v_lshlrev_b32 v196, 16, v143
    v_and_b32 v197, 0xffff0000, v143
    v_fmac_f32 v166, v186, v196
    v_fmac_f32 v167, v186, v197
    v_fmac_f32 v174, v187, v196
    v_fmac_f32 v175, v187, v197
    v_lshlrev_b32 v196, 16, v144
    v_and_b32 v197, 0xffff0000, v144
    v_fmac_f32 v160, v188, v196
    v_fmac_f32 v161, v188, v197
    v_fmac_f32 v168, v189, v196
    v_fmac_f32 v169, v189, v197
    v_lshlrev_b32 v196, 16, v145
    v_and_b32 v197, 0xffff0000, v145
    v_fmac_f32 v162, v188, v196
    v_fmac_f32 v163, v188, v197
    v_fmac_f32 v170, v189, v196
    v_fmac_f32 v171, v189, v197
    v_lshlrev_b32 v196, 16, v146
    v_and_b32 v197, 0xffff0000, v146
    v_fmac_f32 v164, v188, v196
    v_fmac_f32 v165, v188, v197
    v_fmac_f32 v172, v189, v196
    v_fmac_f32 v173, v189, v197
    v_lshlrev_b32 v196, 16, v147
    v_and_b32 v197, 0xffff0000, v147
    v_fmac_f32 v166, v188, v196
    v_fmac_f32 v167, v188, v197
    v_fmac_f32 v174, v189, v196
    v_fmac_f32 v175, v189, v197
    v_lshlrev_b32 v196, 16, v148
    v_and_b32 v197, 0xffff0000, v148
    v_fmac_f32 v160, v190, v196
    v_fmac_f32 v161, v190, v197
    v_fmac_f32 v168, v191, v196
    v_fmac_f32 v169, v191, v197
    v_lshlrev_b32 v196, 16, v149
    v_and_b32 v197, 0xffff0000, v149
    v_fmac_f32 v162, v190, v196
    v_fmac_f32 v163, v190, v197
    v_fmac_f32 v170, v191, v196
    v_fmac_f32 v171, v191, v197
    v_lshlrev_b32 v196, 16, v150
    v_and_b32 v197, 0xffff0000, v150
    v_fmac_f32 v164, v190, v196
    v_fmac_f32 v165, v190, v197
    v_fmac_f32 v172, v191, v196
    v_fmac_f32 v173, v191, v197
    v_lshlrev_b32 v196, 16, v151
    v_and_b32 v197, 0xffff0000, v151
    v_fmac_f32 v166, v190, v196
    v_fmac_f32 v167, v190, v197
    v_fmac_f32 v174, v191, v196
    v_fmac_f32 v175, v191, v197
    v_lshlrev_b32 v196, 16, v152
    v_and_b32 v197, 0xffff0000, v152
    v_fmac_f32 v160, v192, v196
    v_fmac_f32 v161, v192, v197
    v_fmac_f32 v168, v193, v196
    v_fmac_f32 v169, v193, v197
    v_lshlrev_b32 v196, 16, v153
    v_and_b32 v197, 0xffff0000, v153
    v_fmac_f32 v162, v192, v196
    v_fmac_f32 v163, v192, v197
    v_fmac_f32 v170, v193, v196
    v_fmac_f32 v171, v193, v197
    v_lshlrev_b32 v196, 16, v154
    v_and_b32 v197, 0xffff0000, v154
    v_fmac_f32 v164, v192, v196
    v_fmac_f32 v165, v192, v197
    v_fmac_f32 v172, v193, v196
    v_fmac_f32 v173, v193, v197
    v_lshlrev_b32 v196, 16, v155
    v_and_b32 v197, 0xffff0000, v155
    v_fmac_f32 v166, v192, v196
    v_fmac_f32 v167, v192, v197
    v_fmac_f32 v174, v193, v196
    v_fmac_f32 v175, v193, v197
    v_lshlrev_b32 v196, 16, v156
    v_and_b32 v197, 0xffff0000, v156
    v_fmac_f32 v160, v194, v196
    v_fmac_f32 v161, v194, v197
    v_fmac_f32 v168, v195, v196
    v_fmac_f32 v169, v195, v197
    v_lshlrev_b32 v196, 16, v157
    v_and_b32 v197, 0xffff0000, v157
    v_fmac_f32 v162, v194, v196
    v_fmac_f32 v163, v194, v197
    v_fmac_f32 v170, v195, v196
    v_fmac_f32 v171, v195, v197
    v_lshlrev_b32 v196, 16, v158
    v_and_b32 v197, 0xffff0000, v158
    v_fmac_f32 v164, v194, v196
    v_fmac_f32 v165, v194, v197
    v_fmac_f32 v172, v195, v196
    v_fmac_f32 v173, v195, v197
    v_lshlrev_b32 v196, 16, v159
    v_and_b32 v197, 0xffff0000, v159
    v_fmac_f32 v166, v194, v196
    v_fmac_f32 v167, v194, v197
    v_fmac_f32 v174, v195, v196
    v_fmac_f32 v175, v195, v197
    s_nop 0
    v_add_f32_dpp v202, v202, v202 row_shr:1 row_mask:0xf bank_mask:0xf
    v_add_f32_dpp v203, v203, v203 row_shr:1 row_mask:0xf bank_mask:0xf
    s_nop 0
    v_add_f32_dpp v202, v202, v202 row_shr:2 row_mask:0xf bank_mask:0xf
    v_add_f32_dpp v203, v203, v203 row_shr:2 row_mask:0xf bank_mask:0xf
    s_nop 0
    v_add_f32_dpp v202, v202, v202 row_shr:4 row_mask:0xf bank_mask:0xf
    v_add_f32_dpp v203, v203, v203 row_shr:4 row_mask:0xf bank_mask:0xf
    s_nop 0
    v_add_f32_dpp v202, v202, v202 row_shr:8 row_mask:0xf bank_mask:0xf
    v_add_f32_dpp v203, v203, v203 row_shr:8 row_mask:0xf bank_mask:0xf
    v_lshrrev_b32 v196, 5, v211
    v_lshlrev_b32 v196, 11, v196
    v_and_b32 v197, 31, v211
    v_lshl_add_u32 v196, v197, 5, v196
    ds_write_b128 v196, v[160:163] offset:0
    ds_write_b128 v196, v[164:167] offset:16
    ds_write_b128 v196, v[168:171] offset:1024
    ds_write_b128 v196, v[172:175] offset:1040
    v_mov_b32 v180, v200
    v_mov_b32 v181, v202
    v_mov_b32 v182, v201
    v_mov_b32 v183, v203
    v_cmp_eq_u32 vcc, 15, v212
    s_and_saveexec_b64 s[34:35], vcc
    s_lshl_b32 s29, s26, 4
    v_mov_b32 v197, s29
    ds_write_b128 v197, v[180:183] offset:16384
    s_mov_b64 exec, s[34:35]
    s_waitcnt lgkmcnt(0)
    s_barrier
    v_mov_b32 v197, 0
    ds_read_b128 v[32:35], v197 offset:16384
    ds_read_b128 v[36:39], v197 offset:16400
    ds_read_b128 v[40:43], v197 offset:16416
    ds_read_b128 v[44:47], v197 offset:16432
    v_lshlrev_b32 v196, 2, v211
    ds_read_b32 v64, v196 offset:0
    ds_read_b32 v65, v196 offset:1024
    ds_read_b32 v66, v196 offset:2048
    ds_read_b32 v67, v196 offset:3072
    ds_read_b32 v68, v196 offset:4096
    ds_read_b32 v69, v196 offset:5120
    ds_read_b32 v70, v196 offset:6144
    ds_read_b32 v71, v196 offset:7168
    ds_read_b32 v72, v196 offset:8192
    ds_read_b32 v73, v196 offset:9216
    ds_read_b32 v74, v196 offset:10240
    ds_read_b32 v75, v196 offset:11264
    ds_read_b32 v76, v196 offset:12288
    ds_read_b32 v77, v196 offset:13312
    ds_read_b32 v78, v196 offset:14336
    ds_read_b32 v79, v196 offset:15360
    s_waitcnt lgkmcnt(0)
    v_max_f32 v198, v32, v36
    v_max3_f32 v198, v198, v40, v44
    v_sub_f32 v32, v32, v198
    v_exp_f32 v32, v32
    v_sub_f32 v36, v36, v198
    v_exp_f32 v36, v36
    v_sub_f32 v40, v40, v198
    v_exp_f32 v40, v40
    v_sub_f32 v44, v44, v198
    v_exp_f32 v44, v44
    s_nop 0
    v_mul_f32 v199, v32, v33
    v_fmac_f32 v199, v36, v37
    v_fmac_f32 v199, v40, v41
    v_fmac_f32 v199, v44, v45
    v_mov_b32 v96, v198
    v_mov_b32 v97, v199
    v_add_f32 v176, v64, v66
    v_mul_f32 v176, v176, v32
    v_add_f32 v198, v68, v70
    v_fmac_f32 v176, v198, v36
    v_add_f32 v198, v72, v74
    v_fmac_f32 v176, v198, v40
    v_add_f32 v198, v76, v78
    v_fmac_f32 v176, v198, v44
    v_max_f32 v198, v34, v38
    v_max3_f32 v198, v198, v42, v46
    v_sub_f32 v34, v34, v198
    v_exp_f32 v34, v34
    v_sub_f32 v38, v38, v198
    v_exp_f32 v38, v38
    v_sub_f32 v42, v42, v198
    v_exp_f32 v42, v42
    v_sub_f32 v46, v46, v198
    v_exp_f32 v46, v46
    s_nop 0
    v_mul_f32 v199, v34, v35
    v_fmac_f32 v199, v38, v39
    v_fmac_f32 v199, v42, v43
    v_fmac_f32 v199, v46, v47
    v_mov_b32 v98, v198
    v_mov_b32 v99, v199
    v_add_f32 v177, v65, v67
    v_mul_f32 v177, v177, v34
    v_add_f32 v198, v69, v71
    v_fmac_f32 v177, v198, v38
    v_add_f32 v198, v73, v75
    v_fmac_f32 v177, v198, v42
    v_add_f32 v198, v77, v79
    v_fmac_f32 v177, v198, v46
    s_mul_i32 s29, s2, 2112
    s_add_u32 s29, s29, 65536
    buffer_store_dword v176, v196, s[12:15], s29 offen
    buffer_store_dword v177, v196, s[12:15], s29 offen offset:1056
    v_cmp_eq_u32 vcc, 0, v211
    s_and_saveexec_b64 s[34:35], vcc
    buffer_store_dwordx2 v[96:97], v196, s[12:15], s29 offen offset:1024
    buffer_store_dwordx2 v[98:99], v196, s[12:15], s29 offen offset:2080
LB_end:
    s_endpgm
.globl out_kernel
.p2align 8
.type out_kernel,@function
out_kernel:
    s_cmp_ge_u32 s2, 92
    s_cbranch_scc1 LC_end
    s_load_dwordx2 s[4:5], s[0:1], 0
    s_load_dwordx2 s[6:7], s[0:1], 32
    s_load_dwordx4 s[8:11], s[0:1], 64
    s_load_dwordx4 s[12:15], s[0:1], 80
    v_and_b32 v1, 63, v0
    v_lshrrev_b32 v2, 6, v0
    s_nop 0
    v_readfirstlane_b32 s3, v2
    s_waitcnt lgkmcnt(0)
    s_mov_b32 s16, s6
    s_mov_b32 s17, s7
    s_mov_b32 s18, 3670016
    s_mov_b32 s20, s2
    s_sub_u32 s21, s2, 64
    s_cmp_ge_u32 s2, 64
    s_cselect_b32 s16, s8, s16
    s_cselect_b32 s17, s9, s17
    s_cselect_b32 s18, 1605632, s18
    s_cselect_b32 s20, s21, s20
    s_and_b32 s17, s17, 0xffff
    s_mov_b32 s19, 0x20000
    s_mov_b32 s24, s4
    s_and_b32 s25, s5, 0xffff
    s_mov_b32 s26, 1792
    s_mov_b32 s27, 0x20000
    s_mov_b32 s28, s14
    s_and_b32 s29, s15, 0xffff
    s_mov_b32 s30, 1073741824
    s_mov_b32 s31, 0x20000
    s_mov_b32 s32, s10
    s_and_b32 s33, s11, 0xffff
    s_mov_b32 s34, 1792
    s_mov_b32 s35, 0x20000
    s_mov_b32 s36, s12
    s_and_b32 s37, s13, 0xffff
    s_mov_b32 s38, 256
    s_mov_b32 s39, 0x20000
    s_lshl_b32 s21, s20, 6
    s_lshl_b32 s22, s3, 4
    s_add_u32 s21, s21, s22
    s_mul_i32 s21, s21, 896
    v_lshlrev_b32 v3, 4, v1
    v_mov_b32 v4, 0x7fffff00
    v_cmp_gt_u32 vcc, 56, v1
    s_nop 1
    v_cndmask_b32 v3, v4, v3, vcc
    buffer_load_dwordx4 v[64:67], v3, s[16:19], s21 offen
    s_add_u32 s21, s21, 896
    buffer_load_dwordx4 v[68:71], v3, s[16:19], s21 offen
    s_add_u32 s21, s21, 896
    buffer_load_dwordx4 v[72:75], v3, s[16:19], s21 offen
    s_add_u32 s21, s21, 896
    buffer_load_dwordx4 v[76:79], v3, s[16:19], s21 offen
    s_add_u32 s21, s21, 896
    buffer_load_dwordx4 v[80:83], v3, s[16:19], s21 offen
    s_add_u32 s21, s21, 896
    buffer_load_dwordx4 v[84:87], v3, s[16:19], s21 offen
    s_add_u32 s21, s21, 896
    buffer_load_dwordx4 v[88:91], v3, s[16:19], s21 offen
    s_add_u32 s21, s21, 896
    buffer_load_dwordx4 v[92:95], v3, s[16:19], s21 offen
    s_add_u32 s21, s21, 896
    buffer_load_dwordx4 v[96:99], v3, s[16:19], s21 offen
    s_add_u32 s21, s21, 896
    buffer_load_dwordx4 v[100:103], v3, s[16:19], s21 offen
    s_add_u32 s21, s21, 896
    buffer_load_dwordx4 v[104:107], v3, s[16:19], s21 offen
    s_add_u32 s21, s21, 896
    buffer_load_dwordx4 v[108:111], v3, s[16:19], s21 offen
    s_add_u32 s21, s21, 896
    buffer_load_dwordx4 v[112:115], v3, s[16:19], s21 offen
    s_add_u32 s21, s21, 896
    buffer_load_dwordx4 v[116:119], v3, s[16:19], s21 offen
    s_add_u32 s21, s21, 896
    buffer_load_dwordx4 v[120:123], v3, s[16:19], s21 offen
    s_add_u32 s21, s21, 896
    buffer_load_dwordx4 v[124:127], v3, s[16:19], s21 offen
    s_cmp_ge_u32 s2, 64
    s_cbranch_scc1 LC_ffn
    s_lshr_b32 s22, s2, 2
    s_and_b32 s23, s2, 3
    s_lshr_b32 s40, s22, 1
    s_and_b32 s41, s22, 1
    s_lshl_b32 s42, s40, 6
    s_add_u32 s42, s42, s41
    s_mul_i32 s42, s42, 1056
    s_add_u32 s42, s42, 65536
    s_add_u32 s43, s42, 540672
    v_and_b32 v5, 31, v1
    v_mul_u32_u24 v5, 2112, v5
    buffer_load_dwordx2 v[8:9], v5, s[28:31], s42 offen offset:1024
    buffer_load_dwordx2 v[10:11], v5, s[28:31], s43 offen offset:1024
    s_mul_i32 s44, s3, 16896
    s_lshl_b32 s45, s23, 8
    s_add_u32 s44, s44, s45
    v_lshlrev_b32 v6, 2, v1
    v_add_u32 v6, s44, v6
    buffer_load_dword v16, v6, s[28:31], s42 offen offset:0
    buffer_load_dword v17, v6, s[28:31], s42 offen offset:2112
    buffer_load_dword v24, v6, s[28:31], s43 offen offset:0
    buffer_load_dword v25, v6, s[28:31], s43 offen offset:2112
    v_add_u32 v7, 4224, v6
    v_add_u32 v12, 8448, v6
    v_add_u32 v13, 12672, v6
    buffer_load_dword v18, v7, s[28:31], s42 offen offset:0
    buffer_load_dword v19, v7, s[28:31], s42 offen offset:2112
    buffer_load_dword v20, v12, s[28:31], s42 offen offset:0
    buffer_load_dword v21, v12, s[28:31], s42 offen offset:2112
    buffer_load_dword v22, v13, s[28:31], s42 offen offset:0
    buffer_load_dword v23, v13, s[28:31], s42 offen offset:2112
    buffer_load_dword v26, v7, s[28:31], s43 offen offset:0
    buffer_load_dword v27, v7, s[28:31], s43 offen offset:2112
    buffer_load_dword v28, v12, s[28:31], s43 offen offset:0
    buffer_load_dword v29, v12, s[28:31], s43 offen offset:2112
    buffer_load_dword v30, v13, s[28:31], s43 offen offset:0
    buffer_load_dword v31, v13, s[28:31], s43 offen offset:2112
    s_waitcnt vmcnt(16)
    v_mov_b32 v32, v8
    ds_swizzle_b32 v33, v32 offset:1055
    s_waitcnt lgkmcnt(0)
    v_max_f32 v32, v32, v33
    ds_swizzle_b32 v33, v32 offset:2079
    s_waitcnt lgkmcnt(0)
    v_max_f32 v32, v32, v33
    ds_swizzle_b32 v33, v32 offset:4127
    s_waitcnt lgkmcnt(0)
    v_max_f32 v32, v32, v33
    ds_swizzle_b32 v33, v32 offset:8223
    s_waitcnt lgkmcnt(0)
    v_max_f32 v32, v32, v33
    ds_swizzle_b32 v33, v32 offset:16415
    s_waitcnt lgkmcnt(0)
    v_max_f32 v32, v32, v33
    v_sub_f32 v8, v8, v32
    v_exp_f32 v8, v8
    s_nop 0
    v_mul_f32 v9, v8, v9
    ds_swizzle_b32 v33, v9 offset:1055
    s_waitcnt lgkmcnt(0)
    v_add_f32 v9, v9, v33
    ds_swizzle_b32 v33, v9 offset:2079
    s_waitcnt lgkmcnt(0)
    v_add_f32 v9, v9, v33
    ds_swizzle_b32 v33, v9 offset:4127
    s_waitcnt lgkmcnt(0)
    v_add_f32 v9, v9, v33
    ds_swizzle_b32 v33, v9 offset:8223
    s_waitcnt lgkmcnt(0)
    v_add_f32 v9, v9, v33
    ds_swizzle_b32 v33, v9 offset:16415
    s_waitcnt lgkmcnt(0)
    v_add_f32 v9, v9, v33
    v_rcp_f32 v9, v9
    v_mov_b32 v32, v10
    ds_swizzle_b32 v33, v32 offset:1055
    s_waitcnt lgkmcnt(0)
    v_max_f32 v32, v32, v33
    ds_swizzle_b32 v33, v32 offset:2079
    s_waitcnt lgkmcnt(0)
    v_max_f32 v32, v32, v33
    ds_swizzle_b32 v33, v32 offset:4127
    s_waitcnt lgkmcnt(0)
    v_max_f32 v32, v32, v33
    ds_swizzle_b32 v33, v32 offset:8223
    s_waitcnt lgkmcnt(0)
    v_max_f32 v32, v32, v33
    ds_swizzle_b32 v33, v32 offset:16415
    s_waitcnt lgkmcnt(0)
    v_max_f32 v32, v32, v33
    v_sub_f32 v10, v10, v32
    v_exp_f32 v10, v10
    s_nop 0
    v_mul_f32 v11, v10, v11
    ds_swizzle_b32 v33, v11 offset:1055
    s_waitcnt lgkmcnt(0)
    v_add_f32 v11, v11, v33
    ds_swizzle_b32 v33, v11 offset:2079
    s_waitcnt lgkmcnt(0)
    v_add_f32 v11, v11, v33
    ds_swizzle_b32 v33, v11 offset:4127
    s_waitcnt lgkmcnt(0)
    v_add_f32 v11, v11, v33
    ds_swizzle_b32 v33, v11 offset:8223
    s_waitcnt lgkmcnt(0)
    v_add_f32 v11, v11, v33
    ds_swizzle_b32 v33, v11 offset:16415
    s_waitcnt lgkmcnt(0)
    v_add_f32 v11, v11, v33
    v_rcp_f32 v11, v11
    s_lshl_b32 s46, s3, 3
    s_waitcnt vmcnt(0)
    v_mov_b32 v34, 0
    s_add_u32 s47, s46, 0
    s_nop 0
    v_readlane_b32 s48, v8, s47
    s_nop 1
    v_fmac_f32 v34, s48, v16
    s_add_u32 s47, s46, 1
    s_nop 0
    v_readlane_b32 s48, v8, s47
    s_nop 1
    v_fmac_f32 v34, s48, v17
    s_add_u32 s47, s46, 2
    s_nop 0
    v_readlane_b32 s48, v8, s47
    s_nop 1
    v_fmac_f32 v34, s48, v18
    s_add_u32 s47, s46, 3
    s_nop 0
    v_readlane_b32 s48, v8, s47
    s_nop 1
    v_fmac_f32 v34, s48, v19
    s_add_u32 s47, s46, 4
    s_nop 0
    v_readlane_b32 s48, v8, s47
    s_nop 1
    v_fmac_f32 v34, s48, v20
    s_add_u32 s47, s46, 5
    s_nop 0
    v_readlane_b32 s48, v8, s47
    s_nop 1
    v_fmac_f32 v34, s48, v21
    s_add_u32 s47, s46, 6
    s_nop 0
    v_readlane_b32 s48, v8, s47
    s_nop 1
    v_fmac_f32 v34, s48, v22
    s_add_u32 s47, s46, 7
    s_nop 0
    v_readlane_b32 s48, v8, s47
    s_nop 1
    v_fmac_f32 v34, s48, v23
    v_mov_b32 v35, 0
    s_add_u32 s47, s46, 0
    s_nop 0
    v_readlane_b32 s48, v10, s47
    s_nop 1
    v_fmac_f32 v35, s48, v24
    s_add_u32 s47, s46, 1
    s_nop 0
    v_readlane_b32 s48, v10, s47
    s_nop 1
    v_fmac_f32 v35, s48, v25
    s_add_u32 s47, s46, 2
    s_nop 0
    v_readlane_b32 s48, v10, s47
    s_nop 1
    v_fmac_f32 v35, s48, v26
    s_add_u32 s47, s46, 3
    s_nop 0
    v_readlane_b32 s48, v10, s47
    s_nop 1
    v_fmac_f32 v35, s48, v27
    s_add_u32 s47, s46, 4
    s_nop 0
    v_readlane_b32 s48, v10, s47
    s_nop 1
    v_fmac_f32 v35, s48, v28
    s_add_u32 s47, s46, 5
    s_nop 0
    v_readlane_b32 s48, v10, s47
    s_nop 1
    v_fmac_f32 v35, s48, v29
    s_add_u32 s47, s46, 6
    s_nop 0
    v_readlane_b32 s48, v10, s47
    s_nop 1
    v_fmac_f32 v35, s48, v30
    s_add_u32 s47, s46, 7
    s_nop 0
    v_readlane_b32 s48, v10, s47
    s_nop 1
    v_fmac_f32 v35, s48, v31
    v_lshlrev_b32 v5, 2, v1
    s_lshl_b32 s47, s3, 9
    v_add_u32 v5, s47, v5
    ds_write_b32 v5, v34 offset:1024
    ds_write_b32 v5, v35 offset:1280
    s_waitcnt lgkmcnt(0)
    s_barrier
    v_cmp_gt_u32 vcc, 128, v0
    s_and_saveexec_b64 s[50:51], vcc
    s_cbranch_execz LC_a1
    v_lshlrev_b32 v5, 2, v0
    ds_read_b32 v36, v5 offset:1024
    ds_read_b32 v37, v5 offset:1536
    ds_read_b32 v38, v5 offset:2048
    ds_read_b32 v39, v5 offset:2560
    s_waitcnt lgkmcnt(0)
    v_add_f32 v36, v36, v37
    v_add_f32 v38, v38, v39
    v_add_f32 v36, v36, v38
    v_cmp_gt_u32 vcc, 64, v0
    s_nop 1
    v_cndmask_b32 v37, v11, v9, vcc
    v_mul_f32 v36, v36, v37
    v_cvt_pk_bf16_f32 v37, v36, v36
    v_lshlrev_b32 v36, 16, v37
    v_and_b32 v5, 63, v0
    v_lshlrev_b32 v5, 3, v5
    v_lshrrev_b32 v37, 6, v0
    v_lshl_add_u32 v5, v37, 2, v5
    ds_write_b32 v5, v36
LC_a1:
    s_mov_b64 exec, s[50:51]
    s_branch LC_gemv
LC_ffn:
    v_cmp_gt_u32 vcc, 128, v0
    s_and_saveexec_b64 s[50:51], vcc
    s_cbranch_execz LC_f1
    v_lshrrev_b32 v37, 6, v0
    v_and_b32 v5, 63, v0
    v_mul_u32_u24 v6, 15360, v37
    v_lshl_add_u32 v6, v5, 1, v6
    s_lshl_b32 s22, s20, 7
    s_add_u32 s22, s22, 8192
    buffer_load_ushort v8, v6, s[28:31], s22 offen
    buffer_load_ushort v9, v6, s[28:31], s22 offen offset:3584
    s_waitcnt vmcnt(0)
    v_lshlrev_b32 v8, 16, v8
    v_lshlrev_b32 v9, 16, v9
    v_mul_f32 v10, v8, v8
    v_mul_f32 v10, v10, v8
    v_mov_b32 v11, 0x3d372713
    v_fma_f32 v10, v10, v11, v8
    v_mul_f32 v10, 0x40135761, v10
    v_exp_f32 v10, v10
    s_nop 0
    v_add_f32 v10, 1.0, v10
    v_rcp_f32 v10, v10
    s_nop 0
    v_fma_f32 v10, v10, -2.0, 2.0
    v_mul_f32 v10, v10, v8
    v_mul_f32 v10, 0.5, v10
    v_cvt_pk_bf16_f32 v11, v10, v10
    v_lshlrev_b32 v10, 16, v11
    v_mul_f32 v10, v10, v9
    v_cvt_pk_bf16_f32 v11, v10, v10
    v_lshlrev_b32 v10, 16, v11
    v_lshlrev_b32 v5, 3, v5
    v_lshl_add_u32 v5, v37, 2, v5
    ds_write_b32 v5, v10
LC_f1:
    s_mov_b64 exec, s[50:51]
LC_gemv:
    s_waitcnt vmcnt(0) lgkmcnt(0)
    s_barrier
    s_lshl_b32 s22, s3, 7
    v_mov_b32 v5, s22
    ds_read_b64 v[128:129], v5 offset:0
    ds_read_b64 v[130:131], v5 offset:8
    ds_read_b64 v[132:133], v5 offset:16
    ds_read_b64 v[134:135], v5 offset:24
    ds_read_b64 v[136:137], v5 offset:32
    ds_read_b64 v[138:139], v5 offset:40
    ds_read_b64 v[140:141], v5 offset:48
    ds_read_b64 v[142:143], v5 offset:56
    ds_read_b64 v[144:145], v5 offset:64
    ds_read_b64 v[146:147], v5 offset:72
    ds_read_b64 v[148:149], v5 offset:80
    ds_read_b64 v[150:151], v5 offset:88
    ds_read_b64 v[152:153], v5 offset:96
    ds_read_b64 v[154:155], v5 offset:104
    ds_read_b64 v[156:157], v5 offset:112
    ds_read_b64 v[158:159], v5 offset:120
    v_mov_b32 v40, 0
    v_mov_b32 v41, 0
    v_mov_b32 v42, 0
    v_mov_b32 v43, 0
    v_mov_b32 v44, 0
    v_mov_b32 v45, 0
    v_mov_b32 v46, 0
    v_mov_b32 v47, 0
    v_mov_b32 v48, 0
    v_mov_b32 v49, 0
    v_mov_b32 v50, 0
    v_mov_b32 v51, 0
    v_mov_b32 v52, 0
    v_mov_b32 v53, 0
    v_mov_b32 v54, 0
    v_mov_b32 v55, 0
    s_waitcnt lgkmcnt(0)
    v_lshlrev_b32 v36, 16, v64
    v_and_b32 v37, 0xffff0000, v64
    v_fmac_f32 v40, v128, v36
    v_fmac_f32 v41, v128, v37
    v_fmac_f32 v48, v129, v36
    v_fmac_f32 v49, v129, v37
    v_lshlrev_b32 v36, 16, v65
    v_and_b32 v37, 0xffff0000, v65
    v_fmac_f32 v42, v128, v36
    v_fmac_f32 v43, v128, v37
    v_fmac_f32 v50, v129, v36
    v_fmac_f32 v51, v129, v37
    v_lshlrev_b32 v36, 16, v66
    v_and_b32 v37, 0xffff0000, v66
    v_fmac_f32 v44, v128, v36
    v_fmac_f32 v45, v128, v37
    v_fmac_f32 v52, v129, v36
    v_fmac_f32 v53, v129, v37
    v_lshlrev_b32 v36, 16, v67
    v_and_b32 v37, 0xffff0000, v67
    v_fmac_f32 v46, v128, v36
    v_fmac_f32 v47, v128, v37
    v_fmac_f32 v54, v129, v36
    v_fmac_f32 v55, v129, v37
    v_lshlrev_b32 v36, 16, v68
    v_and_b32 v37, 0xffff0000, v68
    v_fmac_f32 v40, v130, v36
    v_fmac_f32 v41, v130, v37
    v_fmac_f32 v48, v131, v36
    v_fmac_f32 v49, v131, v37
    v_lshlrev_b32 v36, 16, v69
    v_and_b32 v37, 0xffff0000, v69
    v_fmac_f32 v42, v130, v36
    v_fmac_f32 v43, v130, v37
    v_fmac_f32 v50, v131, v36
    v_fmac_f32 v51, v131, v37
    v_lshlrev_b32 v36, 16, v70
    v_and_b32 v37, 0xffff0000, v70
    v_fmac_f32 v44, v130, v36
    v_fmac_f32 v45, v130, v37
    v_fmac_f32 v52, v131, v36
    v_fmac_f32 v53, v131, v37
    v_lshlrev_b32 v36, 16, v71
    v_and_b32 v37, 0xffff0000, v71
    v_fmac_f32 v46, v130, v36
    v_fmac_f32 v47, v130, v37
    v_fmac_f32 v54, v131, v36
    v_fmac_f32 v55, v131, v37
    v_lshlrev_b32 v36, 16, v72
    v_and_b32 v37, 0xffff0000, v72
    v_fmac_f32 v40, v132, v36
    v_fmac_f32 v41, v132, v37
    v_fmac_f32 v48, v133, v36
    v_fmac_f32 v49, v133, v37
    v_lshlrev_b32 v36, 16, v73
    v_and_b32 v37, 0xffff0000, v73
    v_fmac_f32 v42, v132, v36
    v_fmac_f32 v43, v132, v37
    v_fmac_f32 v50, v133, v36
    v_fmac_f32 v51, v133, v37
    v_lshlrev_b32 v36, 16, v74
    v_and_b32 v37, 0xffff0000, v74
    v_fmac_f32 v44, v132, v36
    v_fmac_f32 v45, v132, v37
    v_fmac_f32 v52, v133, v36
    v_fmac_f32 v53, v133, v37
    v_lshlrev_b32 v36, 16, v75
    v_and_b32 v37, 0xffff0000, v75
    v_fmac_f32 v46, v132, v36
    v_fmac_f32 v47, v132, v37
    v_fmac_f32 v54, v133, v36
    v_fmac_f32 v55, v133, v37
    v_lshlrev_b32 v36, 16, v76
    v_and_b32 v37, 0xffff0000, v76
    v_fmac_f32 v40, v134, v36
    v_fmac_f32 v41, v134, v37
    v_fmac_f32 v48, v135, v36
    v_fmac_f32 v49, v135, v37
    v_lshlrev_b32 v36, 16, v77
    v_and_b32 v37, 0xffff0000, v77
    v_fmac_f32 v42, v134, v36
    v_fmac_f32 v43, v134, v37
    v_fmac_f32 v50, v135, v36
    v_fmac_f32 v51, v135, v37
    v_lshlrev_b32 v36, 16, v78
    v_and_b32 v37, 0xffff0000, v78
    v_fmac_f32 v44, v134, v36
    v_fmac_f32 v45, v134, v37
    v_fmac_f32 v52, v135, v36
    v_fmac_f32 v53, v135, v37
    v_lshlrev_b32 v36, 16, v79
    v_and_b32 v37, 0xffff0000, v79
    v_fmac_f32 v46, v134, v36
    v_fmac_f32 v47, v134, v37
    v_fmac_f32 v54, v135, v36
    v_fmac_f32 v55, v135, v37
    v_lshlrev_b32 v36, 16, v80
    v_and_b32 v37, 0xffff0000, v80
    v_fmac_f32 v40, v136, v36
    v_fmac_f32 v41, v136, v37
    v_fmac_f32 v48, v137, v36
    v_fmac_f32 v49, v137, v37
    v_lshlrev_b32 v36, 16, v81
    v_and_b32 v37, 0xffff0000, v81
    v_fmac_f32 v42, v136, v36
    v_fmac_f32 v43, v136, v37
    v_fmac_f32 v50, v137, v36
    v_fmac_f32 v51, v137, v37
    v_lshlrev_b32 v36, 16, v82
    v_and_b32 v37, 0xffff0000, v82
    v_fmac_f32 v44, v136, v36
    v_fmac_f32 v45, v136, v37
    v_fmac_f32 v52, v137, v36
    v_fmac_f32 v53, v137, v37
    v_lshlrev_b32 v36, 16, v83
    v_and_b32 v37, 0xffff0000, v83
    v_fmac_f32 v46, v136, v36
    v_fmac_f32 v47, v136, v37
    v_fmac_f32 v54, v137, v36
    v_fmac_f32 v55, v137, v37
    v_lshlrev_b32 v36, 16, v84
    v_and_b32 v37, 0xffff0000, v84
    v_fmac_f32 v40, v138, v36
    v_fmac_f32 v41, v138, v37
    v_fmac_f32 v48, v139, v36
    v_fmac_f32 v49, v139, v37
    v_lshlrev_b32 v36, 16, v85
    v_and_b32 v37, 0xffff0000, v85
    v_fmac_f32 v42, v138, v36
    v_fmac_f32 v43, v138, v37
    v_fmac_f32 v50, v139, v36
    v_fmac_f32 v51, v139, v37
    v_lshlrev_b32 v36, 16, v86
    v_and_b32 v37, 0xffff0000, v86
    v_fmac_f32 v44, v138, v36
    v_fmac_f32 v45, v138, v37
    v_fmac_f32 v52, v139, v36
    v_fmac_f32 v53, v139, v37
    v_lshlrev_b32 v36, 16, v87
    v_and_b32 v37, 0xffff0000, v87
    v_fmac_f32 v46, v138, v36
    v_fmac_f32 v47, v138, v37
    v_fmac_f32 v54, v139, v36
    v_fmac_f32 v55, v139, v37
    v_lshlrev_b32 v36, 16, v88
    v_and_b32 v37, 0xffff0000, v88
    v_fmac_f32 v40, v140, v36
    v_fmac_f32 v41, v140, v37
    v_fmac_f32 v48, v141, v36
    v_fmac_f32 v49, v141, v37
    v_lshlrev_b32 v36, 16, v89
    v_and_b32 v37, 0xffff0000, v89
    v_fmac_f32 v42, v140, v36
    v_fmac_f32 v43, v140, v37
    v_fmac_f32 v50, v141, v36
    v_fmac_f32 v51, v141, v37
    v_lshlrev_b32 v36, 16, v90
    v_and_b32 v37, 0xffff0000, v90
    v_fmac_f32 v44, v140, v36
    v_fmac_f32 v45, v140, v37
    v_fmac_f32 v52, v141, v36
    v_fmac_f32 v53, v141, v37
    v_lshlrev_b32 v36, 16, v91
    v_and_b32 v37, 0xffff0000, v91
    v_fmac_f32 v46, v140, v36
    v_fmac_f32 v47, v140, v37
    v_fmac_f32 v54, v141, v36
    v_fmac_f32 v55, v141, v37
    v_lshlrev_b32 v36, 16, v92
    v_and_b32 v37, 0xffff0000, v92
    v_fmac_f32 v40, v142, v36
    v_fmac_f32 v41, v142, v37
    v_fmac_f32 v48, v143, v36
    v_fmac_f32 v49, v143, v37
    v_lshlrev_b32 v36, 16, v93
    v_and_b32 v37, 0xffff0000, v93
    v_fmac_f32 v42, v142, v36
    v_fmac_f32 v43, v142, v37
    v_fmac_f32 v50, v143, v36
    v_fmac_f32 v51, v143, v37
    v_lshlrev_b32 v36, 16, v94
    v_and_b32 v37, 0xffff0000, v94
    v_fmac_f32 v44, v142, v36
    v_fmac_f32 v45, v142, v37
    v_fmac_f32 v52, v143, v36
    v_fmac_f32 v53, v143, v37
    v_lshlrev_b32 v36, 16, v95
    v_and_b32 v37, 0xffff0000, v95
    v_fmac_f32 v46, v142, v36
    v_fmac_f32 v47, v142, v37
    v_fmac_f32 v54, v143, v36
    v_fmac_f32 v55, v143, v37
    v_lshlrev_b32 v36, 16, v96
    v_and_b32 v37, 0xffff0000, v96
    v_fmac_f32 v40, v144, v36
    v_fmac_f32 v41, v144, v37
    v_fmac_f32 v48, v145, v36
    v_fmac_f32 v49, v145, v37
    v_lshlrev_b32 v36, 16, v97
    v_and_b32 v37, 0xffff0000, v97
    v_fmac_f32 v42, v144, v36
    v_fmac_f32 v43, v144, v37
    v_fmac_f32 v50, v145, v36
    v_fmac_f32 v51, v145, v37
    v_lshlrev_b32 v36, 16, v98
    v_and_b32 v37, 0xffff0000, v98
    v_fmac_f32 v44, v144, v36
    v_fmac_f32 v45, v144, v37
    v_fmac_f32 v52, v145, v36
    v_fmac_f32 v53, v145, v37
    v_lshlrev_b32 v36, 16, v99
    v_and_b32 v37, 0xffff0000, v99
    v_fmac_f32 v46, v144, v36
    v_fmac_f32 v47, v144, v37
    v_fmac_f32 v54, v145, v36
    v_fmac_f32 v55, v145, v37
    v_lshlrev_b32 v36, 16, v100
    v_and_b32 v37, 0xffff0000, v100
    v_fmac_f32 v40, v146, v36
    v_fmac_f32 v41, v146, v37
    v_fmac_f32 v48, v147, v36
    v_fmac_f32 v49, v147, v37
    v_lshlrev_b32 v36, 16, v101
    v_and_b32 v37, 0xffff0000, v101
    v_fmac_f32 v42, v146, v36
    v_fmac_f32 v43, v146, v37
    v_fmac_f32 v50, v147, v36
    v_fmac_f32 v51, v147, v37
    v_lshlrev_b32 v36, 16, v102
    v_and_b32 v37, 0xffff0000, v102
    v_fmac_f32 v44, v146, v36
    v_fmac_f32 v45, v146, v37
    v_fmac_f32 v52, v147, v36
    v_fmac_f32 v53, v147, v37
    v_lshlrev_b32 v36, 16, v103
    v_and_b32 v37, 0xffff0000, v103
    v_fmac_f32 v46, v146, v36
    v_fmac_f32 v47, v146, v37
    v_fmac_f32 v54, v147, v36
    v_fmac_f32 v55, v147, v37
    v_lshlrev_b32 v36, 16, v104
    v_and_b32 v37, 0xffff0000, v104
    v_fmac_f32 v40, v148, v36
    v_fmac_f32 v41, v148, v37
    v_fmac_f32 v48, v149, v36
    v_fmac_f32 v49, v149, v37
    v_lshlrev_b32 v36, 16, v105
    v_and_b32 v37, 0xffff0000, v105
    v_fmac_f32 v42, v148, v36
    v_fmac_f32 v43, v148, v37
    v_fmac_f32 v50, v149, v36
    v_fmac_f32 v51, v149, v37
    v_lshlrev_b32 v36, 16, v106
    v_and_b32 v37, 0xffff0000, v106
    v_fmac_f32 v44, v148, v36
    v_fmac_f32 v45, v148, v37
    v_fmac_f32 v52, v149, v36
    v_fmac_f32 v53, v149, v37
    v_lshlrev_b32 v36, 16, v107
    v_and_b32 v37, 0xffff0000, v107
    v_fmac_f32 v46, v148, v36
    v_fmac_f32 v47, v148, v37
    v_fmac_f32 v54, v149, v36
    v_fmac_f32 v55, v149, v37
    v_lshlrev_b32 v36, 16, v108
    v_and_b32 v37, 0xffff0000, v108
    v_fmac_f32 v40, v150, v36
    v_fmac_f32 v41, v150, v37
    v_fmac_f32 v48, v151, v36
    v_fmac_f32 v49, v151, v37
    v_lshlrev_b32 v36, 16, v109
    v_and_b32 v37, 0xffff0000, v109
    v_fmac_f32 v42, v150, v36
    v_fmac_f32 v43, v150, v37
    v_fmac_f32 v50, v151, v36
    v_fmac_f32 v51, v151, v37
    v_lshlrev_b32 v36, 16, v110
    v_and_b32 v37, 0xffff0000, v110
    v_fmac_f32 v44, v150, v36
    v_fmac_f32 v45, v150, v37
    v_fmac_f32 v52, v151, v36
    v_fmac_f32 v53, v151, v37
    v_lshlrev_b32 v36, 16, v111
    v_and_b32 v37, 0xffff0000, v111
    v_fmac_f32 v46, v150, v36
    v_fmac_f32 v47, v150, v37
    v_fmac_f32 v54, v151, v36
    v_fmac_f32 v55, v151, v37
    v_lshlrev_b32 v36, 16, v112
    v_and_b32 v37, 0xffff0000, v112
    v_fmac_f32 v40, v152, v36
    v_fmac_f32 v41, v152, v37
    v_fmac_f32 v48, v153, v36
    v_fmac_f32 v49, v153, v37
    v_lshlrev_b32 v36, 16, v113
    v_and_b32 v37, 0xffff0000, v113
    v_fmac_f32 v42, v152, v36
    v_fmac_f32 v43, v152, v37
    v_fmac_f32 v50, v153, v36
    v_fmac_f32 v51, v153, v37
    v_lshlrev_b32 v36, 16, v114
    v_and_b32 v37, 0xffff0000, v114
    v_fmac_f32 v44, v152, v36
    v_fmac_f32 v45, v152, v37
    v_fmac_f32 v52, v153, v36
    v_fmac_f32 v53, v153, v37
    v_lshlrev_b32 v36, 16, v115
    v_and_b32 v37, 0xffff0000, v115
    v_fmac_f32 v46, v152, v36
    v_fmac_f32 v47, v152, v37
    v_fmac_f32 v54, v153, v36
    v_fmac_f32 v55, v153, v37
    v_lshlrev_b32 v36, 16, v116
    v_and_b32 v37, 0xffff0000, v116
    v_fmac_f32 v40, v154, v36
    v_fmac_f32 v41, v154, v37
    v_fmac_f32 v48, v155, v36
    v_fmac_f32 v49, v155, v37
    v_lshlrev_b32 v36, 16, v117
    v_and_b32 v37, 0xffff0000, v117
    v_fmac_f32 v42, v154, v36
    v_fmac_f32 v43, v154, v37
    v_fmac_f32 v50, v155, v36
    v_fmac_f32 v51, v155, v37
    v_lshlrev_b32 v36, 16, v118
    v_and_b32 v37, 0xffff0000, v118
    v_fmac_f32 v44, v154, v36
    v_fmac_f32 v45, v154, v37
    v_fmac_f32 v52, v155, v36
    v_fmac_f32 v53, v155, v37
    v_lshlrev_b32 v36, 16, v119
    v_and_b32 v37, 0xffff0000, v119
    v_fmac_f32 v46, v154, v36
    v_fmac_f32 v47, v154, v37
    v_fmac_f32 v54, v155, v36
    v_fmac_f32 v55, v155, v37
    v_lshlrev_b32 v36, 16, v120
    v_and_b32 v37, 0xffff0000, v120
    v_fmac_f32 v40, v156, v36
    v_fmac_f32 v41, v156, v37
    v_fmac_f32 v48, v157, v36
    v_fmac_f32 v49, v157, v37
    v_lshlrev_b32 v36, 16, v121
    v_and_b32 v37, 0xffff0000, v121
    v_fmac_f32 v42, v156, v36
    v_fmac_f32 v43, v156, v37
    v_fmac_f32 v50, v157, v36
    v_fmac_f32 v51, v157, v37
    v_lshlrev_b32 v36, 16, v122
    v_and_b32 v37, 0xffff0000, v122
    v_fmac_f32 v44, v156, v36
    v_fmac_f32 v45, v156, v37
    v_fmac_f32 v52, v157, v36
    v_fmac_f32 v53, v157, v37
    v_lshlrev_b32 v36, 16, v123
    v_and_b32 v37, 0xffff0000, v123
    v_fmac_f32 v46, v156, v36
    v_fmac_f32 v47, v156, v37
    v_fmac_f32 v54, v157, v36
    v_fmac_f32 v55, v157, v37
    v_lshlrev_b32 v36, 16, v124
    v_and_b32 v37, 0xffff0000, v124
    v_fmac_f32 v40, v158, v36
    v_fmac_f32 v41, v158, v37
    v_fmac_f32 v48, v159, v36
    v_fmac_f32 v49, v159, v37
    v_lshlrev_b32 v36, 16, v125
    v_and_b32 v37, 0xffff0000, v125
    v_fmac_f32 v42, v158, v36
    v_fmac_f32 v43, v158, v37
    v_fmac_f32 v50, v159, v36
    v_fmac_f32 v51, v159, v37
    v_lshlrev_b32 v36, 16, v126
    v_and_b32 v37, 0xffff0000, v126
    v_fmac_f32 v44, v158, v36
    v_fmac_f32 v45, v158, v37
    v_fmac_f32 v52, v159, v36
    v_fmac_f32 v53, v159, v37
    v_lshlrev_b32 v36, 16, v127
    v_and_b32 v37, 0xffff0000, v127
    v_fmac_f32 v46, v158, v36
    v_fmac_f32 v47, v158, v37
    v_fmac_f32 v54, v159, v36
    v_fmac_f32 v55, v159, v37
    s_mul_i32 s22, s3, 3584
    v_lshlrev_b32 v5, 5, v1
    v_add_u32 v5, s22, v5
    v_cmp_gt_u32 vcc, 56, v1
    s_and_saveexec_b64 s[50:51], vcc
    ds_write_b128 v5, v[40:43] offset:4096
    ds_write_b128 v5, v[44:47] offset:4112
    ds_write_b128 v5, v[48:51] offset:5888
    ds_write_b128 v5, v[52:55] offset:5904
    s_mov_b64 exec, s[50:51]
    s_waitcnt lgkmcnt(0)
    s_barrier
    v_lshlrev_b32 v5, 4, v0
    v_cmp_gt_u32 vcc, 224, v0
    s_and_saveexec_b64 s[50:51], vcc
    s_cbranch_execz LC_g1
    ds_read_b128 v[8:11], v5 offset:4096
    ds_read_b128 v[12:15], v5 offset:7680
    ds_read_b128 v[16:19], v5 offset:11264
    ds_read_b128 v[20:23], v5 offset:14848
    s_waitcnt lgkmcnt(0)
    v_add_f32 v8, v8, v12
    v_add_f32 v16, v16, v20
    v_add_f32 v8, v8, v16
    v_add_f32 v9, v9, v13
    v_add_f32 v17, v17, v21
    v_add_f32 v9, v9, v17
    v_add_f32 v10, v10, v14
    v_add_f32 v18, v18, v22
    v_add_f32 v10, v10, v18
    v_add_f32 v11, v11, v15
    v_add_f32 v19, v19, v23
    v_add_f32 v11, v11, v19
    s_mul_i32 s22, s2, 3584
    s_add_u32 s22, s22, 2097152
    buffer_store_dwordx4 v[8:11], v5, s[28:31], s22 offen sc1
LC_g1:
    s_mov_b64 exec, s[50:51]
    s_waitcnt vmcnt(0)
    s_barrier
    v_cmp_eq_u32 vcc, 0, v0
    s_and_saveexec_b64 s[50:51], vcc
    s_cbranch_execz LC_c1
    v_mov_b32 v6, 1
    v_mov_b32 v7, 0
    buffer_atomic_add v6, v7, s[36:39], 0 offen sc0 sc1
    s_waitcnt vmcnt(0)
    ds_write_b32 v7, v6 offset:20480
LC_c1:
    s_mov_b64 exec, s[50:51]
    s_waitcnt lgkmcnt(0)
    s_barrier
    v_mov_b32 v7, 0
    ds_read_b32 v6, v7 offset:20480
    s_waitcnt lgkmcnt(0)
    v_readfirstlane_b32 s22, v6
    s_cmp_lg_u32 s22, 91
    s_cbranch_scc1 LC_end
    v_cmp_gt_u32 vcc, 224, v0
    s_and_saveexec_b64 s[50:51], vcc
    s_cbranch_execz LC_end
    v_lshlrev_b32 v6, 3, v0
    buffer_load_dwordx2 v[40:41], v6, s[24:27], 0 offen
    v_mov_b32 v8, 0
    v_mov_b32 v9, 0
    v_mov_b32 v10, 0
    v_mov_b32 v11, 0
    v_mov_b32 v12, 0
    v_mov_b32 v13, 0
    v_mov_b32 v14, 0
    v_mov_b32 v15, 0
    s_mov_b32 s22, 2097152
    buffer_load_dwordx4 v[64:67], v5, s[28:31], s22 offen sc1
    s_add_u32 s22, s22, 3584
    buffer_load_dwordx4 v[68:71], v5, s[28:31], s22 offen sc1
    s_add_u32 s22, s22, 3584
    buffer_load_dwordx4 v[72:75], v5, s[28:31], s22 offen sc1
    s_add_u32 s22, s22, 3584
    buffer_load_dwordx4 v[76:79], v5, s[28:31], s22 offen sc1
    s_add_u32 s22, s22, 3584
    buffer_load_dwordx4 v[80:83], v5, s[28:31], s22 offen sc1
    s_add_u32 s22, s22, 3584
    buffer_load_dwordx4 v[84:87], v5, s[28:31], s22 offen sc1
    s_add_u32 s22, s22, 3584
    buffer_load_dwordx4 v[88:91], v5, s[28:31], s22 offen sc1
    s_add_u32 s22, s22, 3584
    buffer_load_dwordx4 v[92:95], v5, s[28:31], s22 offen sc1
    s_add_u32 s22, s22, 3584
    buffer_load_dwordx4 v[96:99], v5, s[28:31], s22 offen sc1
    s_add_u32 s22, s22, 3584
    buffer_load_dwordx4 v[100:103], v5, s[28:31], s22 offen sc1
    s_add_u32 s22, s22, 3584
    buffer_load_dwordx4 v[104:107], v5, s[28:31], s22 offen sc1
    s_add_u32 s22, s22, 3584
    buffer_load_dwordx4 v[108:111], v5, s[28:31], s22 offen sc1
    s_add_u32 s22, s22, 3584
    buffer_load_dwordx4 v[112:115], v5, s[28:31], s22 offen sc1
    s_add_u32 s22, s22, 3584
    buffer_load_dwordx4 v[116:119], v5, s[28:31], s22 offen sc1
    s_add_u32 s22, s22, 3584
    buffer_load_dwordx4 v[120:123], v5, s[28:31], s22 offen sc1
    s_add_u32 s22, s22, 3584
    buffer_load_dwordx4 v[124:127], v5, s[28:31], s22 offen sc1
    s_add_u32 s22, s22, 3584
    buffer_load_dwordx4 v[128:131], v5, s[28:31], s22 offen sc1
    s_add_u32 s22, s22, 3584
    buffer_load_dwordx4 v[132:135], v5, s[28:31], s22 offen sc1
    s_add_u32 s22, s22, 3584
    buffer_load_dwordx4 v[136:139], v5, s[28:31], s22 offen sc1
    s_add_u32 s22, s22, 3584
    buffer_load_dwordx4 v[140:143], v5, s[28:31], s22 offen sc1
    s_add_u32 s22, s22, 3584
    buffer_load_dwordx4 v[144:147], v5, s[28:31], s22 offen sc1
    s_add_u32 s22, s22, 3584
    buffer_load_dwordx4 v[148:151], v5, s[28:31], s22 offen sc1
    s_add_u32 s22, s22, 3584
    buffer_load_dwordx4 v[152:155], v5, s[28:31], s22 offen sc1
    s_add_u32 s22, s22, 3584
    buffer_load_dwordx4 v[156:159], v5, s[28:31], s22 offen sc1
    s_add_u32 s22, s22, 3584
    buffer_load_dwordx4 v[160:163], v5, s[28:31], s22 offen sc1
    s_add_u32 s22, s22, 3584
    buffer_load_dwordx4 v[164:167], v5, s[28:31], s22 offen sc1
    s_add_u32 s22, s22, 3584
    buffer_load_dwordx4 v[168:171], v5, s[28:31], s22 offen sc1
    s_add_u32 s22, s22, 3584
    buffer_load_dwordx4 v[172:175], v5, s[28:31], s22 offen sc1
    s_add_u32 s22, s22, 3584
    buffer_load_dwordx4 v[176:179], v5, s[28:31], s22 offen sc1
    s_add_u32 s22, s22, 3584
    buffer_load_dwordx4 v[180:183], v5, s[28:31], s22 offen sc1
    s_add_u32 s22, s22, 3584
    buffer_load_dwordx4 v[184:187], v5, s[28:31], s22 offen sc1
    s_add_u32 s22, s22, 3584
    buffer_load_dwordx4 v[188:191], v5, s[28:31], s22 offen sc1
    s_add_u32 s22, s22, 3584
    s_waitcnt vmcnt(31)
    v_add_f32 v8, v8, v64
    v_add_f32 v9, v9, v65
    v_add_f32 v10, v10, v66
    v_add_f32 v11, v11, v67
    s_waitcnt vmcnt(30)
    v_add_f32 v8, v8, v68
    v_add_f32 v9, v9, v69
    v_add_f32 v10, v10, v70
    v_add_f32 v11, v11, v71
    s_waitcnt vmcnt(29)
    v_add_f32 v8, v8, v72
    v_add_f32 v9, v9, v73
    v_add_f32 v10, v10, v74
    v_add_f32 v11, v11, v75
    s_waitcnt vmcnt(28)
    v_add_f32 v8, v8, v76
    v_add_f32 v9, v9, v77
    v_add_f32 v10, v10, v78
    v_add_f32 v11, v11, v79
    s_waitcnt vmcnt(27)
    v_add_f32 v8, v8, v80
    v_add_f32 v9, v9, v81
    v_add_f32 v10, v10, v82
    v_add_f32 v11, v11, v83
    s_waitcnt vmcnt(26)
    v_add_f32 v8, v8, v84
    v_add_f32 v9, v9, v85
    v_add_f32 v10, v10, v86
    v_add_f32 v11, v11, v87
    s_waitcnt vmcnt(25)
    v_add_f32 v8, v8, v88
    v_add_f32 v9, v9, v89
    v_add_f32 v10, v10, v90
    v_add_f32 v11, v11, v91
    s_waitcnt vmcnt(24)
    v_add_f32 v8, v8, v92
    v_add_f32 v9, v9, v93
    v_add_f32 v10, v10, v94
    v_add_f32 v11, v11, v95
    s_waitcnt vmcnt(23)
    v_add_f32 v8, v8, v96
    v_add_f32 v9, v9, v97
    v_add_f32 v10, v10, v98
    v_add_f32 v11, v11, v99
    s_waitcnt vmcnt(22)
    v_add_f32 v8, v8, v100
    v_add_f32 v9, v9, v101
    v_add_f32 v10, v10, v102
    v_add_f32 v11, v11, v103
    s_waitcnt vmcnt(21)
    v_add_f32 v8, v8, v104
    v_add_f32 v9, v9, v105
    v_add_f32 v10, v10, v106
    v_add_f32 v11, v11, v107
    s_waitcnt vmcnt(20)
    v_add_f32 v8, v8, v108
    v_add_f32 v9, v9, v109
    v_add_f32 v10, v10, v110
    v_add_f32 v11, v11, v111
    s_waitcnt vmcnt(19)
    v_add_f32 v8, v8, v112
    v_add_f32 v9, v9, v113
    v_add_f32 v10, v10, v114
    v_add_f32 v11, v11, v115
    s_waitcnt vmcnt(18)
    v_add_f32 v8, v8, v116
    v_add_f32 v9, v9, v117
    v_add_f32 v10, v10, v118
    v_add_f32 v11, v11, v119
    s_waitcnt vmcnt(17)
    v_add_f32 v8, v8, v120
    v_add_f32 v9, v9, v121
    v_add_f32 v10, v10, v122
    v_add_f32 v11, v11, v123
    s_waitcnt vmcnt(16)
    v_add_f32 v8, v8, v124
    v_add_f32 v9, v9, v125
    v_add_f32 v10, v10, v126
    v_add_f32 v11, v11, v127
    s_waitcnt vmcnt(15)
    v_add_f32 v8, v8, v128
    v_add_f32 v9, v9, v129
    v_add_f32 v10, v10, v130
    v_add_f32 v11, v11, v131
    s_waitcnt vmcnt(14)
    v_add_f32 v8, v8, v132
    v_add_f32 v9, v9, v133
    v_add_f32 v10, v10, v134
    v_add_f32 v11, v11, v135
    s_waitcnt vmcnt(13)
    v_add_f32 v8, v8, v136
    v_add_f32 v9, v9, v137
    v_add_f32 v10, v10, v138
    v_add_f32 v11, v11, v139
    s_waitcnt vmcnt(12)
    v_add_f32 v8, v8, v140
    v_add_f32 v9, v9, v141
    v_add_f32 v10, v10, v142
    v_add_f32 v11, v11, v143
    s_waitcnt vmcnt(11)
    v_add_f32 v8, v8, v144
    v_add_f32 v9, v9, v145
    v_add_f32 v10, v10, v146
    v_add_f32 v11, v11, v147
    s_waitcnt vmcnt(10)
    v_add_f32 v8, v8, v148
    v_add_f32 v9, v9, v149
    v_add_f32 v10, v10, v150
    v_add_f32 v11, v11, v151
    s_waitcnt vmcnt(9)
    v_add_f32 v8, v8, v152
    v_add_f32 v9, v9, v153
    v_add_f32 v10, v10, v154
    v_add_f32 v11, v11, v155
    s_waitcnt vmcnt(8)
    v_add_f32 v8, v8, v156
    v_add_f32 v9, v9, v157
    v_add_f32 v10, v10, v158
    v_add_f32 v11, v11, v159
    s_waitcnt vmcnt(7)
    v_add_f32 v8, v8, v160
    v_add_f32 v9, v9, v161
    v_add_f32 v10, v10, v162
    v_add_f32 v11, v11, v163
    s_waitcnt vmcnt(6)
    v_add_f32 v8, v8, v164
    v_add_f32 v9, v9, v165
    v_add_f32 v10, v10, v166
    v_add_f32 v11, v11, v167
    s_waitcnt vmcnt(5)
    v_add_f32 v8, v8, v168
    v_add_f32 v9, v9, v169
    v_add_f32 v10, v10, v170
    v_add_f32 v11, v11, v171
    s_waitcnt vmcnt(4)
    v_add_f32 v8, v8, v172
    v_add_f32 v9, v9, v173
    v_add_f32 v10, v10, v174
    v_add_f32 v11, v11, v175
    s_waitcnt vmcnt(3)
    v_add_f32 v8, v8, v176
    v_add_f32 v9, v9, v177
    v_add_f32 v10, v10, v178
    v_add_f32 v11, v11, v179
    s_waitcnt vmcnt(2)
    v_add_f32 v8, v8, v180
    v_add_f32 v9, v9, v181
    v_add_f32 v10, v10, v182
    v_add_f32 v11, v11, v183
    s_waitcnt vmcnt(1)
    v_add_f32 v8, v8, v184
    v_add_f32 v9, v9, v185
    v_add_f32 v10, v10, v186
    v_add_f32 v11, v11, v187
    s_waitcnt vmcnt(0)
    v_add_f32 v8, v8, v188
    v_add_f32 v9, v9, v189
    v_add_f32 v10, v10, v190
    v_add_f32 v11, v11, v191
    buffer_load_dwordx4 v[64:67], v5, s[28:31], s22 offen sc1
    s_add_u32 s22, s22, 3584
    buffer_load_dwordx4 v[68:71], v5, s[28:31], s22 offen sc1
    s_add_u32 s22, s22, 3584
    buffer_load_dwordx4 v[72:75], v5, s[28:31], s22 offen sc1
    s_add_u32 s22, s22, 3584
    buffer_load_dwordx4 v[76:79], v5, s[28:31], s22 offen sc1
    s_add_u32 s22, s22, 3584
    buffer_load_dwordx4 v[80:83], v5, s[28:31], s22 offen sc1
    s_add_u32 s22, s22, 3584
    buffer_load_dwordx4 v[84:87], v5, s[28:31], s22 offen sc1
    s_add_u32 s22, s22, 3584
    buffer_load_dwordx4 v[88:91], v5, s[28:31], s22 offen sc1
    s_add_u32 s22, s22, 3584
    buffer_load_dwordx4 v[92:95], v5, s[28:31], s22 offen sc1
    s_add_u32 s22, s22, 3584
    buffer_load_dwordx4 v[96:99], v5, s[28:31], s22 offen sc1
    s_add_u32 s22, s22, 3584
    buffer_load_dwordx4 v[100:103], v5, s[28:31], s22 offen sc1
    s_add_u32 s22, s22, 3584
    buffer_load_dwordx4 v[104:107], v5, s[28:31], s22 offen sc1
    s_add_u32 s22, s22, 3584
    buffer_load_dwordx4 v[108:111], v5, s[28:31], s22 offen sc1
    s_add_u32 s22, s22, 3584
    buffer_load_dwordx4 v[112:115], v5, s[28:31], s22 offen sc1
    s_add_u32 s22, s22, 3584
    buffer_load_dwordx4 v[116:119], v5, s[28:31], s22 offen sc1
    s_add_u32 s22, s22, 3584
    buffer_load_dwordx4 v[120:123], v5, s[28:31], s22 offen sc1
    s_add_u32 s22, s22, 3584
    buffer_load_dwordx4 v[124:127], v5, s[28:31], s22 offen sc1
    s_add_u32 s22, s22, 3584
    buffer_load_dwordx4 v[128:131], v5, s[28:31], s22 offen sc1
    s_add_u32 s22, s22, 3584
    buffer_load_dwordx4 v[132:135], v5, s[28:31], s22 offen sc1
    s_add_u32 s22, s22, 3584
    buffer_load_dwordx4 v[136:139], v5, s[28:31], s22 offen sc1
    s_add_u32 s22, s22, 3584
    buffer_load_dwordx4 v[140:143], v5, s[28:31], s22 offen sc1
    s_add_u32 s22, s22, 3584
    buffer_load_dwordx4 v[144:147], v5, s[28:31], s22 offen sc1
    s_add_u32 s22, s22, 3584
    buffer_load_dwordx4 v[148:151], v5, s[28:31], s22 offen sc1
    s_add_u32 s22, s22, 3584
    buffer_load_dwordx4 v[152:155], v5, s[28:31], s22 offen sc1
    s_add_u32 s22, s22, 3584
    buffer_load_dwordx4 v[156:159], v5, s[28:31], s22 offen sc1
    s_add_u32 s22, s22, 3584
    buffer_load_dwordx4 v[160:163], v5, s[28:31], s22 offen sc1
    s_add_u32 s22, s22, 3584
    buffer_load_dwordx4 v[164:167], v5, s[28:31], s22 offen sc1
    s_add_u32 s22, s22, 3584
    buffer_load_dwordx4 v[168:171], v5, s[28:31], s22 offen sc1
    s_add_u32 s22, s22, 3584
    buffer_load_dwordx4 v[172:175], v5, s[28:31], s22 offen sc1
    s_add_u32 s22, s22, 3584
    buffer_load_dwordx4 v[176:179], v5, s[28:31], s22 offen sc1
    s_add_u32 s22, s22, 3584
    buffer_load_dwordx4 v[180:183], v5, s[28:31], s22 offen sc1
    s_add_u32 s22, s22, 3584
    buffer_load_dwordx4 v[184:187], v5, s[28:31], s22 offen sc1
    s_add_u32 s22, s22, 3584
    buffer_load_dwordx4 v[188:191], v5, s[28:31], s22 offen sc1
    s_add_u32 s22, s22, 3584
    s_waitcnt vmcnt(31)
    v_add_f32 v8, v8, v64
    v_add_f32 v9, v9, v65
    v_add_f32 v10, v10, v66
    v_add_f32 v11, v11, v67
    s_waitcnt vmcnt(30)
    v_add_f32 v8, v8, v68
    v_add_f32 v9, v9, v69
    v_add_f32 v10, v10, v70
    v_add_f32 v11, v11, v71
    s_waitcnt vmcnt(29)
    v_add_f32 v8, v8, v72
    v_add_f32 v9, v9, v73
    v_add_f32 v10, v10, v74
    v_add_f32 v11, v11, v75
    s_waitcnt vmcnt(28)
    v_add_f32 v8, v8, v76
    v_add_f32 v9, v9, v77
    v_add_f32 v10, v10, v78
    v_add_f32 v11, v11, v79
    s_waitcnt vmcnt(27)
    v_add_f32 v8, v8, v80
    v_add_f32 v9, v9, v81
    v_add_f32 v10, v10, v82
    v_add_f32 v11, v11, v83
    s_waitcnt vmcnt(26)
    v_add_f32 v8, v8, v84
    v_add_f32 v9, v9, v85
    v_add_f32 v10, v10, v86
    v_add_f32 v11, v11, v87
    s_waitcnt vmcnt(25)
    v_add_f32 v8, v8, v88
    v_add_f32 v9, v9, v89
    v_add_f32 v10, v10, v90
    v_add_f32 v11, v11, v91
    s_waitcnt vmcnt(24)
    v_add_f32 v8, v8, v92
    v_add_f32 v9, v9, v93
    v_add_f32 v10, v10, v94
    v_add_f32 v11, v11, v95
    s_waitcnt vmcnt(23)
    v_add_f32 v8, v8, v96
    v_add_f32 v9, v9, v97
    v_add_f32 v10, v10, v98
    v_add_f32 v11, v11, v99
    s_waitcnt vmcnt(22)
    v_add_f32 v8, v8, v100
    v_add_f32 v9, v9, v101
    v_add_f32 v10, v10, v102
    v_add_f32 v11, v11, v103
    s_waitcnt vmcnt(21)
    v_add_f32 v8, v8, v104
    v_add_f32 v9, v9, v105
    v_add_f32 v10, v10, v106
    v_add_f32 v11, v11, v107
    s_waitcnt vmcnt(20)
    v_add_f32 v8, v8, v108
    v_add_f32 v9, v9, v109
    v_add_f32 v10, v10, v110
    v_add_f32 v11, v11, v111
    s_waitcnt vmcnt(19)
    v_add_f32 v8, v8, v112
    v_add_f32 v9, v9, v113
    v_add_f32 v10, v10, v114
    v_add_f32 v11, v11, v115
    s_waitcnt vmcnt(18)
    v_add_f32 v8, v8, v116
    v_add_f32 v9, v9, v117
    v_add_f32 v10, v10, v118
    v_add_f32 v11, v11, v119
    s_waitcnt vmcnt(17)
    v_add_f32 v8, v8, v120
    v_add_f32 v9, v9, v121
    v_add_f32 v10, v10, v122
    v_add_f32 v11, v11, v123
    s_waitcnt vmcnt(16)
    v_add_f32 v8, v8, v124
    v_add_f32 v9, v9, v125
    v_add_f32 v10, v10, v126
    v_add_f32 v11, v11, v127
    s_waitcnt vmcnt(15)
    v_add_f32 v8, v8, v128
    v_add_f32 v9, v9, v129
    v_add_f32 v10, v10, v130
    v_add_f32 v11, v11, v131
    s_waitcnt vmcnt(14)
    v_add_f32 v8, v8, v132
    v_add_f32 v9, v9, v133
    v_add_f32 v10, v10, v134
    v_add_f32 v11, v11, v135
    s_waitcnt vmcnt(13)
    v_add_f32 v8, v8, v136
    v_add_f32 v9, v9, v137
    v_add_f32 v10, v10, v138
    v_add_f32 v11, v11, v139
    s_waitcnt vmcnt(12)
    v_add_f32 v8, v8, v140
    v_add_f32 v9, v9, v141
    v_add_f32 v10, v10, v142
    v_add_f32 v11, v11, v143
    s_waitcnt vmcnt(11)
    v_add_f32 v8, v8, v144
    v_add_f32 v9, v9, v145
    v_add_f32 v10, v10, v146
    v_add_f32 v11, v11, v147
    s_waitcnt vmcnt(10)
    v_add_f32 v8, v8, v148
    v_add_f32 v9, v9, v149
    v_add_f32 v10, v10, v150
    v_add_f32 v11, v11, v151
    s_waitcnt vmcnt(9)
    v_add_f32 v8, v8, v152
    v_add_f32 v9, v9, v153
    v_add_f32 v10, v10, v154
    v_add_f32 v11, v11, v155
    s_waitcnt vmcnt(8)
    v_add_f32 v8, v8, v156
    v_add_f32 v9, v9, v157
    v_add_f32 v10, v10, v158
    v_add_f32 v11, v11, v159
    s_waitcnt vmcnt(7)
    v_add_f32 v8, v8, v160
    v_add_f32 v9, v9, v161
    v_add_f32 v10, v10, v162
    v_add_f32 v11, v11, v163
    s_waitcnt vmcnt(6)
    v_add_f32 v8, v8, v164
    v_add_f32 v9, v9, v165
    v_add_f32 v10, v10, v166
    v_add_f32 v11, v11, v167
    s_waitcnt vmcnt(5)
    v_add_f32 v8, v8, v168
    v_add_f32 v9, v9, v169
    v_add_f32 v10, v10, v170
    v_add_f32 v11, v11, v171
    s_waitcnt vmcnt(4)
    v_add_f32 v8, v8, v172
    v_add_f32 v9, v9, v173
    v_add_f32 v10, v10, v174
    v_add_f32 v11, v11, v175
    s_waitcnt vmcnt(3)
    v_add_f32 v8, v8, v176
    v_add_f32 v9, v9, v177
    v_add_f32 v10, v10, v178
    v_add_f32 v11, v11, v179
    s_waitcnt vmcnt(2)
    v_add_f32 v8, v8, v180
    v_add_f32 v9, v9, v181
    v_add_f32 v10, v10, v182
    v_add_f32 v11, v11, v183
    s_waitcnt vmcnt(1)
    v_add_f32 v8, v8, v184
    v_add_f32 v9, v9, v185
    v_add_f32 v10, v10, v186
    v_add_f32 v11, v11, v187
    s_waitcnt vmcnt(0)
    v_add_f32 v8, v8, v188
    v_add_f32 v9, v9, v189
    v_add_f32 v10, v10, v190
    v_add_f32 v11, v11, v191
    buffer_load_dwordx4 v[64:67], v5, s[28:31], s22 offen sc1
    s_add_u32 s22, s22, 3584
    buffer_load_dwordx4 v[68:71], v5, s[28:31], s22 offen sc1
    s_add_u32 s22, s22, 3584
    buffer_load_dwordx4 v[72:75], v5, s[28:31], s22 offen sc1
    s_add_u32 s22, s22, 3584
    buffer_load_dwordx4 v[76:79], v5, s[28:31], s22 offen sc1
    s_add_u32 s22, s22, 3584
    buffer_load_dwordx4 v[80:83], v5, s[28:31], s22 offen sc1
    s_add_u32 s22, s22, 3584
    buffer_load_dwordx4 v[84:87], v5, s[28:31], s22 offen sc1
    s_add_u32 s22, s22, 3584
    buffer_load_dwordx4 v[88:91], v5, s[28:31], s22 offen sc1
    s_add_u32 s22, s22, 3584
    buffer_load_dwordx4 v[92:95], v5, s[28:31], s22 offen sc1
    s_add_u32 s22, s22, 3584
    buffer_load_dwordx4 v[96:99], v5, s[28:31], s22 offen sc1
    s_add_u32 s22, s22, 3584
    buffer_load_dwordx4 v[100:103], v5, s[28:31], s22 offen sc1
    s_add_u32 s22, s22, 3584
    buffer_load_dwordx4 v[104:107], v5, s[28:31], s22 offen sc1
    s_add_u32 s22, s22, 3584
    buffer_load_dwordx4 v[108:111], v5, s[28:31], s22 offen sc1
    s_add_u32 s22, s22, 3584
    buffer_load_dwordx4 v[112:115], v5, s[28:31], s22 offen sc1
    s_add_u32 s22, s22, 3584
    buffer_load_dwordx4 v[116:119], v5, s[28:31], s22 offen sc1
    s_add_u32 s22, s22, 3584
    buffer_load_dwordx4 v[120:123], v5, s[28:31], s22 offen sc1
    s_add_u32 s22, s22, 3584
    buffer_load_dwordx4 v[124:127], v5, s[28:31], s22 offen sc1
    s_add_u32 s22, s22, 3584
    buffer_load_dwordx4 v[128:131], v5, s[28:31], s22 offen sc1
    s_add_u32 s22, s22, 3584
    buffer_load_dwordx4 v[132:135], v5, s[28:31], s22 offen sc1
    s_add_u32 s22, s22, 3584
    buffer_load_dwordx4 v[136:139], v5, s[28:31], s22 offen sc1
    s_add_u32 s22, s22, 3584
    buffer_load_dwordx4 v[140:143], v5, s[28:31], s22 offen sc1
    s_add_u32 s22, s22, 3584
    buffer_load_dwordx4 v[144:147], v5, s[28:31], s22 offen sc1
    s_add_u32 s22, s22, 3584
    buffer_load_dwordx4 v[148:151], v5, s[28:31], s22 offen sc1
    s_add_u32 s22, s22, 3584
    buffer_load_dwordx4 v[152:155], v5, s[28:31], s22 offen sc1
    s_add_u32 s22, s22, 3584
    buffer_load_dwordx4 v[156:159], v5, s[28:31], s22 offen sc1
    s_add_u32 s22, s22, 3584
    buffer_load_dwordx4 v[160:163], v5, s[28:31], s22 offen sc1
    s_add_u32 s22, s22, 3584
    buffer_load_dwordx4 v[164:167], v5, s[28:31], s22 offen sc1
    s_add_u32 s22, s22, 3584
    buffer_load_dwordx4 v[168:171], v5, s[28:31], s22 offen sc1
    s_add_u32 s22, s22, 3584
    buffer_load_dwordx4 v[172:175], v5, s[28:31], s22 offen sc1
    s_add_u32 s22, s22, 3584
    s_waitcnt vmcnt(27)
    v_add_f32 v12, v12, v64
    v_add_f32 v13, v13, v65
    v_add_f32 v14, v14, v66
    v_add_f32 v15, v15, v67
    s_waitcnt vmcnt(26)
    v_add_f32 v12, v12, v68
    v_add_f32 v13, v13, v69
    v_add_f32 v14, v14, v70
    v_add_f32 v15, v15, v71
    s_waitcnt vmcnt(25)
    v_add_f32 v12, v12, v72
    v_add_f32 v13, v13, v73
    v_add_f32 v14, v14, v74
    v_add_f32 v15, v15, v75
    s_waitcnt vmcnt(24)
    v_add_f32 v12, v12, v76
    v_add_f32 v13, v13, v77
    v_add_f32 v14, v14, v78
    v_add_f32 v15, v15, v79
    s_waitcnt vmcnt(23)
    v_add_f32 v12, v12, v80
    v_add_f32 v13, v13, v81
    v_add_f32 v14, v14, v82
    v_add_f32 v15, v15, v83
    s_waitcnt vmcnt(22)
    v_add_f32 v12, v12, v84
    v_add_f32 v13, v13, v85
    v_add_f32 v14, v14, v86
    v_add_f32 v15, v15, v87
    s_waitcnt vmcnt(21)
    v_add_f32 v12, v12, v88
    v_add_f32 v13, v13, v89
    v_add_f32 v14, v14, v90
    v_add_f32 v15, v15, v91
    s_waitcnt vmcnt(20)
    v_add_f32 v12, v12, v92
    v_add_f32 v13, v13, v93
    v_add_f32 v14, v14, v94
    v_add_f32 v15, v15, v95
    s_waitcnt vmcnt(19)
    v_add_f32 v12, v12, v96
    v_add_f32 v13, v13, v97
    v_add_f32 v14, v14, v98
    v_add_f32 v15, v15, v99
    s_waitcnt vmcnt(18)
    v_add_f32 v12, v12, v100
    v_add_f32 v13, v13, v101
    v_add_f32 v14, v14, v102
    v_add_f32 v15, v15, v103
    s_waitcnt vmcnt(17)
    v_add_f32 v12, v12, v104
    v_add_f32 v13, v13, v105
    v_add_f32 v14, v14, v106
    v_add_f32 v15, v15, v107
    s_waitcnt vmcnt(16)
    v_add_f32 v12, v12, v108
    v_add_f32 v13, v13, v109
    v_add_f32 v14, v14, v110
    v_add_f32 v15, v15, v111
    s_waitcnt vmcnt(15)
    v_add_f32 v12, v12, v112
    v_add_f32 v13, v13, v113
    v_add_f32 v14, v14, v114
    v_add_f32 v15, v15, v115
    s_waitcnt vmcnt(14)
    v_add_f32 v12, v12, v116
    v_add_f32 v13, v13, v117
    v_add_f32 v14, v14, v118
    v_add_f32 v15, v15, v119
    s_waitcnt vmcnt(13)
    v_add_f32 v12, v12, v120
    v_add_f32 v13, v13, v121
    v_add_f32 v14, v14, v122
    v_add_f32 v15, v15, v123
    s_waitcnt vmcnt(12)
    v_add_f32 v12, v12, v124
    v_add_f32 v13, v13, v125
    v_add_f32 v14, v14, v126
    v_add_f32 v15, v15, v127
    s_waitcnt vmcnt(11)
    v_add_f32 v12, v12, v128
    v_add_f32 v13, v13, v129
    v_add_f32 v14, v14, v130
    v_add_f32 v15, v15, v131
    s_waitcnt vmcnt(10)
    v_add_f32 v12, v12, v132
    v_add_f32 v13, v13, v133
    v_add_f32 v14, v14, v134
    v_add_f32 v15, v15, v135
    s_waitcnt vmcnt(9)
    v_add_f32 v12, v12, v136
    v_add_f32 v13, v13, v137
    v_add_f32 v14, v14, v138
    v_add_f32 v15, v15, v139
    s_waitcnt vmcnt(8)
    v_add_f32 v12, v12, v140
    v_add_f32 v13, v13, v141
    v_add_f32 v14, v14, v142
    v_add_f32 v15, v15, v143
    s_waitcnt vmcnt(7)
    v_add_f32 v12, v12, v144
    v_add_f32 v13, v13, v145
    v_add_f32 v14, v14, v146
    v_add_f32 v15, v15, v147
    s_waitcnt vmcnt(6)
    v_add_f32 v12, v12, v148
    v_add_f32 v13, v13, v149
    v_add_f32 v14, v14, v150
    v_add_f32 v15, v15, v151
    s_waitcnt vmcnt(5)
    v_add_f32 v12, v12, v152
    v_add_f32 v13, v13, v153
    v_add_f32 v14, v14, v154
    v_add_f32 v15, v15, v155
    s_waitcnt vmcnt(4)
    v_add_f32 v12, v12, v156
    v_add_f32 v13, v13, v157
    v_add_f32 v14, v14, v158
    v_add_f32 v15, v15, v159
    s_waitcnt vmcnt(3)
    v_add_f32 v12, v12, v160
    v_add_f32 v13, v13, v161
    v_add_f32 v14, v14, v162
    v_add_f32 v15, v15, v163
    s_waitcnt vmcnt(2)
    v_add_f32 v12, v12, v164
    v_add_f32 v13, v13, v165
    v_add_f32 v14, v14, v166
    v_add_f32 v15, v15, v167
    s_waitcnt vmcnt(1)
    v_add_f32 v12, v12, v168
    v_add_f32 v13, v13, v169
    v_add_f32 v14, v14, v170
    v_add_f32 v15, v15, v171
    s_waitcnt vmcnt(0)
    v_add_f32 v12, v12, v172
    v_add_f32 v13, v13, v173
    v_add_f32 v14, v14, v174
    v_add_f32 v15, v15, v175
    v_lshlrev_b32 v44, 16, v40
    v_and_b32 v45, 0xffff0000, v40
    v_lshlrev_b32 v46, 16, v41
    v_and_b32 v47, 0xffff0000, v41
    v_cvt_pk_bf16_f32 v48, v8, v8
    v_lshlrev_b32 v8, 16, v48
    v_cvt_pk_bf16_f32 v48, v12, v12
    v_lshlrev_b32 v12, 16, v48
    v_add_f32 v8, v44, v8
    v_cvt_pk_bf16_f32 v48, v8, v8
    v_lshlrev_b32 v8, 16, v48
    v_add_f32 v8, v8, v12
    v_cvt_pk_bf16_f32 v48, v9, v9
    v_lshlrev_b32 v9, 16, v48
    v_cvt_pk_bf16_f32 v48, v13, v13
    v_lshlrev_b32 v13, 16, v48
    v_add_f32 v9, v45, v9
    v_cvt_pk_bf16_f32 v48, v9, v9
    v_lshlrev_b32 v9, 16, v48
    v_add_f32 v9, v9, v13
    v_cvt_pk_bf16_f32 v48, v10, v10
    v_lshlrev_b32 v10, 16, v48
    v_cvt_pk_bf16_f32 v48, v14, v14
    v_lshlrev_b32 v14, 16, v48
    v_add_f32 v10, v46, v10
    v_cvt_pk_bf16_f32 v48, v10, v10
    v_lshlrev_b32 v10, 16, v48
    v_add_f32 v10, v10, v14
    v_cvt_pk_bf16_f32 v48, v11, v11
    v_lshlrev_b32 v11, 16, v48
    v_cvt_pk_bf16_f32 v48, v15, v15
    v_lshlrev_b32 v15, 16, v48
    v_add_f32 v11, v47, v11
    v_cvt_pk_bf16_f32 v48, v11, v11
    v_lshlrev_b32 v11, 16, v48
    v_add_f32 v11, v11, v15
    v_cvt_pk_bf16_f32 v48, v8, v9
    v_cvt_pk_bf16_f32 v49, v10, v11
    buffer_store_dwordx2 v[48:49], v6, s[32:35], 0 offen
LC_end:
    s_endpgm
.section .rodata,"a"
.p2align 6
.amdhsa_kernel proj_kernel
  .amdhsa_next_free_vgpr 160
  .amdhsa_next_free_sgpr 64
  .amdhsa_accum_offset 160
  .amdhsa_group_segment_fixed_size 0
  .amdhsa_kernarg_size 96
  .amdhsa_user_sgpr_count 2
  .amdhsa_user_sgpr_kernarg_segment_ptr 1
  .amdhsa_system_sgpr_workgroup_id_x 1
.end_amdhsa_kernel
.p2align 6
.amdhsa_kernel attn_kernel
  .amdhsa_next_free_vgpr 216
  .amdhsa_next_free_sgpr 64
  .amdhsa_accum_offset 216
  .amdhsa_group_segment_fixed_size 0
  .amdhsa_kernarg_size 96
  .amdhsa_user_sgpr_count 2
  .amdhsa_user_sgpr_kernarg_segment_ptr 1
  .amdhsa_system_sgpr_workgroup_id_x 1
.end_amdhsa_kernel
.p2align 6
.amdhsa_kernel out_kernel
  .amdhsa_next_free_vgpr 200
  .amdhsa_next_free_sgpr 64
  .amdhsa_accum_offset 200
  .amdhsa_group_segment_fixed_size 0
  .amdhsa_kernarg_size 96
  .amdhsa_user_sgpr_count 2
  .amdhsa_user_sgpr_kernarg_segment_ptr 1
  .amdhsa_system_sgpr_workgroup_id_x 1
.end_amdhsa_kernel
```
